```python
import torch

def _softmax(x, axis=-1):
    return torch.softmax(x, dim=axis)
def _gelu(x):
    return torch.nn.functional.gelu(x, approximate="tanh")
def _silu(x):
    return torch.nn.functional.silu(x)
def _sigmoid(x):
    return torch.sigmoid(x)
def _layernorm(x, axis=-1, eps=1e-5):
    m = x.mean(dim=axis, keepdim=True)
    v = x.var(dim=axis, keepdim=True, unbiased=False)
    return (x - m) / torch.sqrt(v + eps)
def _scatter_add(tgt, idx, src, axis=0):
    return tgt.clone().index_add_(axis, idx, src)
def _segment_sum(src, seg, n):
    out = torch.zeros((n,) + src.shape[1:], dtype=src.dtype)
    return out.index_add_(0, seg, src)
def _pad(x, pw):
    flat = tuple(v for pair in reversed(pw) for v in pair)
    return torch.nn.functional.pad(x, flat)

kernel_name = 'parallel_sum__gqa_block_cached__glu_gated_swiglu__decode'

def setup_inputs():

    _w = (lambda a: (lambda t: t.to(torch.bfloat16) if t.is_floating_point() else t)(torch.as_tensor(a)))
    def _A_setup():
        B, Sq, D = 4, 1, 512
        Hq, Hkv, Sk, Dh = 32, 8, 4096, 128
        assert Hq % Hkv == 0, (Hq, Hkv)
        return {
            "x": _w((lambda *s: torch.randn(*s, dtype=torch.bfloat16) * 0.05)(B, Sq, D)),
            "k_cache": _w((lambda *s: torch.randn(*s, dtype=torch.bfloat16) * 1.6)(B, Hkv, Sk, Dh)),
            "v_cache": _w((lambda *s: torch.randn(*s, dtype=torch.bfloat16) * 0.8)(B, Hkv, Sk, Dh)),
            "wq": _w((lambda *s: torch.randn(*s, dtype=torch.bfloat16) * 1.6)(D, Hq * Dh) * (D ** -0.5)),
            "wo": _w((lambda *s: torch.randn(*s, dtype=torch.bfloat16) * 0.8)(Hq * Dh, D) * ((Hq * Dh) ** -0.5)),
        }
    _A_in = _A_setup()

    def _B_setup():
        B, S, D, F = 4, 1, 512, 1792
        return {
            "x": _w((lambda *s: torch.randn(*s, dtype=torch.bfloat16) * 0.05)(B, S, D)),
            "w1": _w((lambda *s: torch.randn(*s, dtype=torch.bfloat16) * 0.4)(D, F) * (2.0 / D) ** 0.5),
            "w3": _w((lambda *s: torch.randn(*s, dtype=torch.bfloat16) * 0.4)(D, F) * (2.0 / D) ** 0.5),
            "w2": _w((lambda *s: torch.randn(*s, dtype=torch.bfloat16) * 0.4)(F, D) * (2.0 / F) ** 0.5),
        }
    _B_in = _B_setup()

    return {
        "A_x": _A_in["x"],
        "A_k_cache": _A_in["k_cache"],
        "A_v_cache": _A_in["v_cache"],
        "A_wq": _A_in["wq"],
        "A_wo": _A_in["wo"],
        "B_x": _B_in["x"],
        "B_w1": _B_in["w1"],
        "B_w3": _B_in["w3"],
        "B_w2": _B_in["w2"],
    }

def reference(A_x, A_k_cache, A_v_cache, A_wq, A_wo, B_x, B_w1, B_w3, B_w2):
    def _A_ref(x, k_cache, v_cache, wq, wo):
        B, Sq, D = x.shape
        Hq, Dh = 32, 128
        Hkv = k_cache.shape[1]
        rep = Hq // Hkv
        q = (lambda x, *d: x.permute(*d))((x @ wq).reshape(B, Sq, Hq, Dh), 0, 2, 1, 3)
        k = (lambda x, n, axis: torch.repeat_interleave(x, n, dim=axis))(k_cache, rep, axis=1)
        v = (lambda x, n, axis: torch.repeat_interleave(x, n, dim=axis))(v_cache, rep, axis=1)
        scores = torch.einsum("bhqd,bhkd->bhqk", q, k) * (Dh ** -0.5)
        p = _softmax(scores, axis=-1)
        o = torch.einsum("bhqk,bhkd->bhqd", p, v)
        return (lambda x, *d: x.permute(*d))(o, 0, 2, 1, 3).reshape(B, Sq, Hq * Dh) @ wo

    def _B_ref(x, w1, w3, w2):
        gate = torch.einsum("bsd,df->bsf", x, w1)
        up = torch.einsum("bsd,df->bsf", x, w3)
        h = _silu(gate) * up
        out = torch.einsum("bsf,fd->bsd", h, w2)
        return out

    x = A_x
    xn = _layernorm(x, axis=-1)
    return x + _A_ref(xn, A_k_cache, A_v_cache, A_wq, A_wo) + _B_ref(xn, B_w1, B_w3, B_w2)
```

```asm
; @launch grid=(256,1,1) block=(768,1,1) lds=28928
.amdgcn_target "amdgcn-amd-amdhsa--gfx950"
.text
.globl parallel_sum__gqa_block_cached__glu_gated_swiglu__decode_kernel
.p2align 8
.type parallel_sum__gqa_block_cached__glu_gated_swiglu__decode_kernel,@function
parallel_sum__gqa_block_cached__glu_gated_swiglu__decode_kernel:
    s_cmp_ge_u32 s2, 256
    s_cbranch_scc1 L_end
    s_load_dwordx16 s[16:31], s[0:1], 0
    s_load_dwordx8 s[32:39], s[0:1], 64
    v_lshrrev_b32 v1, 6, v0
    v_and_b32 v0, 63, v0
    v_readfirstlane_b32 s3, v1
    v_mov_b32 v5, 0
    v_mov_b32 v6, 1
    s_mov_b32 s76, 0x05040100
    s_mov_b32 s77, 0x07060302
    s_mov_b32 s78, 0x3fb8aa3b
    s_mov_b32 s79, 0x3db504f3
    s_mov_b32 s80, 0xbfb8aa3b
    s_mov_b32 s81, 0xffff0000
    v_lshlrev_b32 v2, 2, v0
    s_mov_b64 exec, 0xffff
    ds_write_b32 v2, v5
    s_mov_b64 exec, -1
    v_and_b32 v1, 15, v0
    v_lshrrev_b32 v7, 4, v0
    s_bfe_u32 s92, s2, 0x30003
    s_lshr_b32 s93, s2, 6
    s_and_b32 s94, s2, 7
    s_and_b32 s95, s2, 63
    s_lshr_b32 s96, s2, 6
    s_waitcnt lgkmcnt(0)
    s_load_dwordx2 s[40:41], s[38:39], 0
    s_mov_b32 s56, s38
    s_mov_b32 s57, s39
    s_mov_b32 s58, 0x10000000
    s_mov_b32 s59, 0x20000
    s_cmp_ge_u32 s3, 8
    s_cbranch_scc1 L_helper
    s_mov_b32 s44, s18
    s_mov_b32 s45, s19
    s_mov_b32 s46, 0x2000000
    s_mov_b32 s47, 0x20000
    s_mov_b32 s48, s20
    s_mov_b32 s49, s21
    s_mov_b32 s50, 0x2000000
    s_mov_b32 s51, 0x20000
    s_lshr_b32 s52, s2, 3
    s_lshl_b32 s52, s52, 20
    s_mul_i32 s4, s94, 131072
    s_add_u32 s52, s52, s4
    s_mul_i32 s4, s3, 1024
    s_add_u32 s52, s52, s4
    v_lshrrev_b32 v2, 2, v1
    v_lshlrev_b32 v2, 8, v2
    v_lshl_add_u32 v2, v7, 6, v2
    v_and_b32 v3, 3, v1
    v_lshl_add_u32 v2, v3, 4, v2
    v_lshlrev_b32 v3, 4, v0
    s_add_u32 s53, s52, 0
    buffer_load_dwordx4 v[8:11], v2, s[44:47], s53 offen nt
    s_add_u32 s53, s52, 8192
    buffer_load_dwordx4 v[12:15], v2, s[44:47], s53 offen nt
    s_add_u32 s53, s52, 16384
    buffer_load_dwordx4 v[16:19], v2, s[44:47], s53 offen nt
    s_barrier
    s_waitcnt vmcnt(2)
    s_add_u32 s53, s52, 24576
    buffer_load_dwordx4 v[20:23], v2, s[44:47], s53 offen nt
    s_waitcnt vmcnt(2)
    s_add_u32 s53, s52, 32768
    buffer_load_dwordx4 v[24:27], v2, s[44:47], s53 offen nt
    s_waitcnt vmcnt(2)
    s_add_u32 s53, s52, 40960
    buffer_load_dwordx4 v[28:31], v2, s[44:47], s53 offen nt
    s_waitcnt vmcnt(2)
    s_add_u32 s53, s52, 49152
    buffer_load_dwordx4 v[32:35], v2, s[44:47], s53 offen nt
    s_waitcnt vmcnt(2)
    s_add_u32 s53, s52, 57344
    buffer_load_dwordx4 v[36:39], v2, s[44:47], s53 offen nt
    s_waitcnt vmcnt(2)
    s_add_u32 s53, s52, 65536
    buffer_load_dwordx4 v[40:43], v2, s[44:47], s53 offen nt
    s_waitcnt vmcnt(2)
    s_add_u32 s53, s52, 73728
    buffer_load_dwordx4 v[44:47], v2, s[44:47], s53 offen nt
    s_waitcnt vmcnt(2)
    s_add_u32 s53, s52, 81920
    buffer_load_dwordx4 v[48:51], v2, s[44:47], s53 offen nt
    s_waitcnt vmcnt(2)
    s_add_u32 s53, s52, 90112
    buffer_load_dwordx4 v[52:55], v2, s[44:47], s53 offen nt
    s_waitcnt vmcnt(2)
    s_add_u32 s53, s52, 98304
    buffer_load_dwordx4 v[56:59], v2, s[44:47], s53 offen nt
    s_waitcnt vmcnt(2)
    s_add_u32 s53, s52, 106496
    buffer_load_dwordx4 v[60:63], v2, s[44:47], s53 offen nt
    s_waitcnt vmcnt(2)
    s_add_u32 s53, s52, 114688
    buffer_load_dwordx4 v[64:67], v2, s[44:47], s53 offen nt
    s_waitcnt vmcnt(2)
    s_add_u32 s53, s52, 122880
    buffer_load_dwordx4 v[68:71], v2, s[44:47], s53 offen nt
    s_mov_b64 exec, 1
    ds_add_u32 v5, v6 offset:36
    s_mov_b64 exec, -1
    s_waitcnt vmcnt(2)
    s_add_u32 s53, s52, 0
    buffer_load_dwordx4 v[72:75], v3, s[48:51], s53 offen nt
    s_waitcnt vmcnt(2)
    s_add_u32 s53, s52, 8192
    buffer_load_dwordx4 v[76:79], v3, s[48:51], s53 offen nt
    s_waitcnt vmcnt(2)
    s_add_u32 s53, s52, 16384
    buffer_load_dwordx4 v[80:83], v3, s[48:51], s53 offen nt
    s_waitcnt vmcnt(2)
    s_add_u32 s53, s52, 24576
    buffer_load_dwordx4 v[84:87], v3, s[48:51], s53 offen nt
    s_waitcnt vmcnt(2)
    s_add_u32 s53, s52, 32768
    buffer_load_dwordx4 v[88:91], v3, s[48:51], s53 offen nt
    s_waitcnt vmcnt(2)
    s_add_u32 s53, s52, 40960
    buffer_load_dwordx4 v[92:95], v3, s[48:51], s53 offen nt
    s_mov_b64 exec, 1
    ds_add_u32 v5, v6 offset:40
    s_mov_b64 exec, -1
    s_waitcnt vmcnt(2)
    s_add_u32 s53, s52, 49152
    buffer_load_dwordx4 v[96:99], v3, s[48:51], s53 offen nt
    s_waitcnt vmcnt(2)
    s_add_u32 s53, s52, 57344
    buffer_load_dwordx4 v[100:103], v3, s[48:51], s53 offen nt
    s_waitcnt vmcnt(2)
    s_add_u32 s53, s52, 65536
    buffer_load_dwordx4 v[104:107], v3, s[48:51], s53 offen nt
    s_waitcnt vmcnt(2)
    s_add_u32 s53, s52, 73728
    buffer_load_dwordx4 v[108:111], v3, s[48:51], s53 offen nt
    s_waitcnt lgkmcnt(0)
    s_add_u32 s42, s40, 1
    s_addc_u32 s43, s41, 0
    s_and_b32 s75, s43, 0xff
    s_mov_b32 s5, 0
L_spin1:
    ds_read_b32 v4, v5 offset:0
    s_waitcnt lgkmcnt(0)
    v_readfirstlane_b32 s4, v4
    s_cmp_ge_u32 s4, 1
    s_cbranch_scc1 L_spin1_done
    s_sleep 2
    s_add_u32 s5, s5, 1
    s_cmp_lt_u32 s5, 8000000
    s_cbranch_scc1 L_spin1
L_spin1_done:
    ds_read_b128 v[136:139], v2 offset:256
    s_waitcnt vmcnt(7)
    s_add_u32 s53, s52, 81920
    buffer_load_dwordx4 v[112:115], v3, s[48:51], s53 offen nt
    s_waitcnt lgkmcnt(0)
    v_mfma_f32_16x16x32_bf16 v[8:11], v[8:11], v[136:139], 0
    v_mfma_f32_16x16x32_bf16 v[12:15], v[12:15], v[136:139], 0
    v_mfma_f32_16x16x32_bf16 v[16:19], v[16:19], v[136:139], 0
    v_mfma_f32_16x16x32_bf16 v[20:23], v[20:23], v[136:139], 0
    v_mfma_f32_16x16x32_bf16 v[24:27], v[24:27], v[136:139], 0
    v_mfma_f32_16x16x32_bf16 v[28:31], v[28:31], v[136:139], 0
    v_mfma_f32_16x16x32_bf16 v[32:35], v[32:35], v[136:139], 0
    v_mfma_f32_16x16x32_bf16 v[36:39], v[36:39], v[136:139], 0
    v_mfma_f32_16x16x32_bf16 v[40:43], v[40:43], v[136:139], 0
    v_mfma_f32_16x16x32_bf16 v[44:47], v[44:47], v[136:139], 0
    v_mfma_f32_16x16x32_bf16 v[48:51], v[48:51], v[136:139], 0
    v_mfma_f32_16x16x32_bf16 v[52:55], v[52:55], v[136:139], 0
    v_mfma_f32_16x16x32_bf16 v[56:59], v[56:59], v[136:139], 0
    v_mfma_f32_16x16x32_bf16 v[60:63], v[60:63], v[136:139], 0
    v_mfma_f32_16x16x32_bf16 v[64:67], v[64:67], v[136:139], 0
    v_mfma_f32_16x16x32_bf16 v[68:71], v[68:71], v[136:139], 0
    s_waitcnt vmcnt(7)
    s_add_u32 s53, s52, 90112
    buffer_load_dwordx4 v[116:119], v3, s[48:51], s53 offen nt
    v_mov_b32_dpp v8, v8 quad_perm:[0,0,0,0] row_mask:0xf bank_mask:0xf
    v_mov_b32_dpp v12, v12 quad_perm:[0,0,0,0] row_mask:0xf bank_mask:0xf
    v_mov_b32_dpp v16, v16 quad_perm:[0,0,0,0] row_mask:0xf bank_mask:0xf
    v_mov_b32_dpp v20, v20 quad_perm:[0,0,0,0] row_mask:0xf bank_mask:0xf
    v_add_f32_dpp v8, v9, v8 quad_perm:[1,1,1,1] row_mask:0xf bank_mask:0xf
    v_add_f32_dpp v12, v13, v12 quad_perm:[1,1,1,1] row_mask:0xf bank_mask:0xf
    v_add_f32_dpp v16, v17, v16 quad_perm:[1,1,1,1] row_mask:0xf bank_mask:0xf
    v_add_f32_dpp v20, v21, v20 quad_perm:[1,1,1,1] row_mask:0xf bank_mask:0xf
    v_add_f32_dpp v8, v10, v8 quad_perm:[2,2,2,2] row_mask:0xf bank_mask:0xf
    v_add_f32_dpp v12, v14, v12 quad_perm:[2,2,2,2] row_mask:0xf bank_mask:0xf
    v_add_f32_dpp v16, v18, v16 quad_perm:[2,2,2,2] row_mask:0xf bank_mask:0xf
    v_add_f32_dpp v20, v22, v20 quad_perm:[2,2,2,2] row_mask:0xf bank_mask:0xf
    v_add_f32_dpp v8, v11, v8 quad_perm:[3,3,3,3] row_mask:0xf bank_mask:0xf
    v_add_f32_dpp v12, v15, v12 quad_perm:[3,3,3,3] row_mask:0xf bank_mask:0xf
    v_add_f32_dpp v16, v19, v16 quad_perm:[3,3,3,3] row_mask:0xf bank_mask:0xf
    v_add_f32_dpp v20, v23, v20 quad_perm:[3,3,3,3] row_mask:0xf bank_mask:0xf
    v_mov_b32_dpp v24, v24 quad_perm:[0,0,0,0] row_mask:0xf bank_mask:0xf
    v_mov_b32_dpp v28, v28 quad_perm:[0,0,0,0] row_mask:0xf bank_mask:0xf
    v_mov_b32_dpp v32, v32 quad_perm:[0,0,0,0] row_mask:0xf bank_mask:0xf
    v_mov_b32_dpp v36, v36 quad_perm:[0,0,0,0] row_mask:0xf bank_mask:0xf
    v_add_f32_dpp v24, v25, v24 quad_perm:[1,1,1,1] row_mask:0xf bank_mask:0xf
    v_add_f32_dpp v28, v29, v28 quad_perm:[1,1,1,1] row_mask:0xf bank_mask:0xf
    v_add_f32_dpp v32, v33, v32 quad_perm:[1,1,1,1] row_mask:0xf bank_mask:0xf
    v_add_f32_dpp v36, v37, v36 quad_perm:[1,1,1,1] row_mask:0xf bank_mask:0xf
    v_add_f32_dpp v24, v26, v24 quad_perm:[2,2,2,2] row_mask:0xf bank_mask:0xf
    v_add_f32_dpp v28, v30, v28 quad_perm:[2,2,2,2] row_mask:0xf bank_mask:0xf
    v_add_f32_dpp v32, v34, v32 quad_perm:[2,2,2,2] row_mask:0xf bank_mask:0xf
    v_add_f32_dpp v36, v38, v36 quad_perm:[2,2,2,2] row_mask:0xf bank_mask:0xf
    v_add_f32_dpp v24, v27, v24 quad_perm:[3,3,3,3] row_mask:0xf bank_mask:0xf
    v_add_f32_dpp v28, v31, v28 quad_perm:[3,3,3,3] row_mask:0xf bank_mask:0xf
    v_add_f32_dpp v32, v35, v32 quad_perm:[3,3,3,3] row_mask:0xf bank_mask:0xf
    v_add_f32_dpp v36, v39, v36 quad_perm:[3,3,3,3] row_mask:0xf bank_mask:0xf
    v_mov_b32_dpp v40, v40 quad_perm:[0,0,0,0] row_mask:0xf bank_mask:0xf
    v_mov_b32_dpp v44, v44 quad_perm:[0,0,0,0] row_mask:0xf bank_mask:0xf
    v_mov_b32_dpp v48, v48 quad_perm:[0,0,0,0] row_mask:0xf bank_mask:0xf
    v_mov_b32_dpp v52, v52 quad_perm:[0,0,0,0] row_mask:0xf bank_mask:0xf
    v_add_f32_dpp v40, v41, v40 quad_perm:[1,1,1,1] row_mask:0xf bank_mask:0xf
    v_add_f32_dpp v44, v45, v44 quad_perm:[1,1,1,1] row_mask:0xf bank_mask:0xf
    v_add_f32_dpp v48, v49, v48 quad_perm:[1,1,1,1] row_mask:0xf bank_mask:0xf
    v_add_f32_dpp v52, v53, v52 quad_perm:[1,1,1,1] row_mask:0xf bank_mask:0xf
    v_add_f32_dpp v40, v42, v40 quad_perm:[2,2,2,2] row_mask:0xf bank_mask:0xf
    v_add_f32_dpp v44, v46, v44 quad_perm:[2,2,2,2] row_mask:0xf bank_mask:0xf
    v_add_f32_dpp v48, v50, v48 quad_perm:[2,2,2,2] row_mask:0xf bank_mask:0xf
    v_add_f32_dpp v52, v54, v52 quad_perm:[2,2,2,2] row_mask:0xf bank_mask:0xf
    v_add_f32_dpp v40, v43, v40 quad_perm:[3,3,3,3] row_mask:0xf bank_mask:0xf
    v_add_f32_dpp v44, v47, v44 quad_perm:[3,3,3,3] row_mask:0xf bank_mask:0xf
    v_add_f32_dpp v48, v51, v48 quad_perm:[3,3,3,3] row_mask:0xf bank_mask:0xf
    v_add_f32_dpp v52, v55, v52 quad_perm:[3,3,3,3] row_mask:0xf bank_mask:0xf
    v_mov_b32_dpp v56, v56 quad_perm:[0,0,0,0] row_mask:0xf bank_mask:0xf
    v_mov_b32_dpp v60, v60 quad_perm:[0,0,0,0] row_mask:0xf bank_mask:0xf
    v_mov_b32_dpp v64, v64 quad_perm:[0,0,0,0] row_mask:0xf bank_mask:0xf
    v_mov_b32_dpp v68, v68 quad_perm:[0,0,0,0] row_mask:0xf bank_mask:0xf
    v_add_f32_dpp v56, v57, v56 quad_perm:[1,1,1,1] row_mask:0xf bank_mask:0xf
    v_add_f32_dpp v60, v61, v60 quad_perm:[1,1,1,1] row_mask:0xf bank_mask:0xf
    v_add_f32_dpp v64, v65, v64 quad_perm:[1,1,1,1] row_mask:0xf bank_mask:0xf
    v_add_f32_dpp v68, v69, v68 quad_perm:[1,1,1,1] row_mask:0xf bank_mask:0xf
    v_add_f32_dpp v56, v58, v56 quad_perm:[2,2,2,2] row_mask:0xf bank_mask:0xf
    v_add_f32_dpp v60, v62, v60 quad_perm:[2,2,2,2] row_mask:0xf bank_mask:0xf
    v_add_f32_dpp v64, v66, v64 quad_perm:[2,2,2,2] row_mask:0xf bank_mask:0xf
    v_add_f32_dpp v68, v70, v68 quad_perm:[2,2,2,2] row_mask:0xf bank_mask:0xf
    v_add_f32_dpp v56, v59, v56 quad_perm:[3,3,3,3] row_mask:0xf bank_mask:0xf
    v_add_f32_dpp v60, v63, v60 quad_perm:[3,3,3,3] row_mask:0xf bank_mask:0xf
    v_add_f32_dpp v64, v67, v64 quad_perm:[3,3,3,3] row_mask:0xf bank_mask:0xf
    v_add_f32_dpp v68, v71, v68 quad_perm:[3,3,3,3] row_mask:0xf bank_mask:0xf
    s_waitcnt vmcnt(7)
    s_add_u32 s53, s52, 98304
    buffer_load_dwordx4 v[120:123], v3, s[48:51], s53 offen nt
    v_cvt_pk_bf16_f32 v9, v8, v12
    v_cvt_pk_bf16_f32 v17, v16, v20
    v_cvt_pk_bf16_f32 v25, v24, v28
    v_cvt_pk_bf16_f32 v33, v32, v36
    v_cvt_pk_bf16_f32 v41, v40, v44
    v_cvt_pk_bf16_f32 v49, v48, v52
    v_cvt_pk_bf16_f32 v57, v56, v60
    v_cvt_pk_bf16_f32 v65, v64, v68
    v_lshlrev_b32 v8, 16, v9
    v_and_b32 v12, s81, v9
    v_lshlrev_b32 v16, 16, v17
    v_and_b32 v20, s81, v17
    v_lshlrev_b32 v24, 16, v25
    v_and_b32 v28, s81, v25
    v_lshlrev_b32 v32, 16, v33
    v_and_b32 v36, s81, v33
    v_lshlrev_b32 v40, 16, v41
    v_and_b32 v44, s81, v41
    v_lshlrev_b32 v48, 16, v49
    v_and_b32 v52, s81, v49
    v_lshlrev_b32 v56, 16, v57
    v_and_b32 v60, s81, v57
    v_lshlrev_b32 v64, 16, v65
    v_and_b32 v68, s81, v65
    v_mul_f32 v8, s79, v8
    v_mul_f32 v12, s79, v12
    v_mul_f32 v16, s79, v16
    v_mul_f32 v20, s79, v20
    v_mul_f32 v24, s79, v24
    v_mul_f32 v28, s79, v28
    v_mul_f32 v32, s79, v32
    v_mul_f32 v36, s79, v36
    v_mul_f32 v40, s79, v40
    v_mul_f32 v44, s79, v44
    v_mul_f32 v48, s79, v48
    v_mul_f32 v52, s79, v52
    v_mul_f32 v56, s79, v56
    v_mul_f32 v60, s79, v60
    v_mul_f32 v64, s79, v64
    v_mul_f32 v68, s79, v68
    v_cvt_pk_bf16_f32 v9, v8, v12
    v_cvt_pk_bf16_f32 v17, v16, v20
    v_cvt_pk_bf16_f32 v25, v24, v28
    v_cvt_pk_bf16_f32 v33, v32, v36
    v_cvt_pk_bf16_f32 v41, v40, v44
    v_cvt_pk_bf16_f32 v49, v48, v52
    v_cvt_pk_bf16_f32 v57, v56, v60
    v_cvt_pk_bf16_f32 v65, v64, v68
    v_lshlrev_b32 v8, 16, v9
    v_and_b32 v12, s81, v9
    v_lshlrev_b32 v16, 16, v17
    v_and_b32 v20, s81, v17
    v_lshlrev_b32 v24, 16, v25
    v_and_b32 v28, s81, v25
    v_lshlrev_b32 v32, 16, v33
    v_and_b32 v36, s81, v33
    v_lshlrev_b32 v40, 16, v41
    v_and_b32 v44, s81, v41
    v_lshlrev_b32 v48, 16, v49
    v_and_b32 v52, s81, v49
    v_lshlrev_b32 v56, 16, v57
    v_and_b32 v60, s81, v57
    v_lshlrev_b32 v64, 16, v65
    v_and_b32 v68, s81, v65
    s_waitcnt vmcnt(7)
    s_add_u32 s53, s52, 106496
    buffer_load_dwordx4 v[124:127], v3, s[48:51], s53 offen nt
    v_max3_f32 v148, v8, v12, v16
    v_max3_f32 v150, v20, v24, v28
    v_max3_f32 v148, v148, v32, v36
    v_max3_f32 v150, v150, v40, v44
    v_max3_f32 v148, v148, v48, v52
    v_max3_f32 v150, v150, v56, v60
    v_max3_f32 v148, v148, v64, v68
    v_max_f32 v148, v148, v150
    v_mov_b32 v150, v148
    s_nop 1
    v_permlane16_swap_b32 v148, v150
    v_max_f32 v148, v148, v150
    v_mov_b32 v150, v148
    s_nop 1
    v_permlane32_swap_b32 v148, v150
    v_max_f32 v148, v148, v150
    v_mul_f32 v151, s80, v148
    v_fma_f32 v8, v8, s78, v151
    v_fma_f32 v12, v12, s78, v151
    v_fma_f32 v16, v16, s78, v151
    v_fma_f32 v20, v20, s78, v151
    v_fma_f32 v24, v24, s78, v151
    v_fma_f32 v28, v28, s78, v151
    v_fma_f32 v32, v32, s78, v151
    v_fma_f32 v36, v36, s78, v151
    v_fma_f32 v40, v40, s78, v151
    v_fma_f32 v44, v44, s78, v151
    v_fma_f32 v48, v48, s78, v151
    v_fma_f32 v52, v52, s78, v151
    v_fma_f32 v56, v56, s78, v151
    v_fma_f32 v60, v60, s78, v151
    v_fma_f32 v64, v64, s78, v151
    v_fma_f32 v68, v68, s78, v151
    v_exp_f32 v8, v8
    v_exp_f32 v12, v12
    v_exp_f32 v16, v16
    v_exp_f32 v20, v20
    v_exp_f32 v24, v24
    v_exp_f32 v28, v28
    v_exp_f32 v32, v32
    v_exp_f32 v36, v36
    v_exp_f32 v40, v40
    v_exp_f32 v44, v44
    v_exp_f32 v48, v48
    v_exp_f32 v52, v52
    v_exp_f32 v56, v56
    v_exp_f32 v60, v60
    v_exp_f32 v64, v64
    v_exp_f32 v68, v68
    s_waitcnt vmcnt(7)
    s_add_u32 s53, s52, 114688
    buffer_load_dwordx4 v[128:131], v3, s[48:51], s53 offen nt
    v_cvt_pk_bf16_f32 v140, v8, v12
    v_cvt_pk_bf16_f32 v141, v16, v20
    v_cvt_pk_bf16_f32 v142, v24, v28
    v_cvt_pk_bf16_f32 v143, v32, v36
    v_cvt_pk_bf16_f32 v144, v40, v44
    v_cvt_pk_bf16_f32 v145, v48, v52
    v_cvt_pk_bf16_f32 v146, v56, v60
    v_cvt_pk_bf16_f32 v147, v64, v68
    v_add_f32 v149, v8, v12
    v_add_f32 v150, v16, v20
    v_add_f32 v149, v149, v24
    v_add_f32 v150, v150, v28
    v_add_f32 v149, v149, v32
    v_add_f32 v150, v150, v36
    v_add_f32 v149, v149, v40
    v_add_f32 v150, v150, v44
    v_add_f32 v149, v149, v48
    v_add_f32 v150, v150, v52
    v_add_f32 v149, v149, v56
    v_add_f32 v150, v150, v60
    v_add_f32 v149, v149, v64
    v_add_f32 v150, v150, v68
    v_add_f32 v149, v149, v150
    v_mov_b32 v150, v149
    s_nop 1
    v_permlane16_swap_b32 v149, v150
    v_add_f32 v149, v149, v150
    v_mov_b32 v150, v149
    s_nop 1
    v_permlane32_swap_b32 v149, v150
    v_add_f32 v149, v149, v150
    s_mul_i32 s4, s3, 2176
    v_lshl_add_u32 v152, v0, 2, s4
    v_lshrrev_b32 v153, 2, v0
    v_lshlrev_b32 v153, 6, v153
    s_lshl_b32 s4, s3, 3
    v_add_u32 v153, s4, v153
    s_mov_b64 exec, 0x1111
    ds_write_b64 v153, v[148:149] offset:1280
    s_waitcnt lgkmcnt(0)
    s_mov_b64 exec, 1
    ds_add_u32 v5, v6 offset:28
    s_mov_b64 exec, -1
    s_waitcnt vmcnt(7)
    s_add_u32 s53, s52, 122880
    buffer_load_dwordx4 v[132:135], v3, s[48:51], s53 offen nt
    s_mov_b64 exec, 1
    ds_add_u32 v5, v6 offset:8
    s_mov_b64 exec, -1
    v_perm_b32 v8, v76, v72, s76
    v_perm_b32 v12, v76, v72, s77
    v_perm_b32 v16, v77, v73, s76
    v_perm_b32 v20, v77, v73, s77
    v_perm_b32 v24, v78, v74, s76
    v_perm_b32 v28, v78, v74, s77
    v_perm_b32 v32, v79, v75, s76
    v_perm_b32 v36, v79, v75, s77
    v_perm_b32 v9, v84, v80, s76
    v_perm_b32 v13, v84, v80, s77
    v_perm_b32 v17, v85, v81, s76
    v_perm_b32 v21, v85, v81, s77
    v_perm_b32 v25, v86, v82, s76
    v_perm_b32 v29, v86, v82, s77
    v_perm_b32 v33, v87, v83, s76
    v_perm_b32 v37, v87, v83, s77
    v_perm_b32 v10, v92, v88, s76
    v_perm_b32 v14, v92, v88, s77
    v_perm_b32 v18, v93, v89, s76
    v_perm_b32 v22, v93, v89, s77
    v_perm_b32 v26, v94, v90, s76
    v_perm_b32 v30, v94, v90, s77
    v_perm_b32 v34, v95, v91, s76
    v_perm_b32 v38, v95, v91, s77
    v_perm_b32 v11, v100, v96, s76
    v_perm_b32 v15, v100, v96, s77
    v_perm_b32 v19, v101, v97, s76
    v_perm_b32 v23, v101, v97, s77
    v_perm_b32 v27, v102, v98, s76
    v_perm_b32 v31, v102, v98, s77
    v_perm_b32 v35, v103, v99, s76
    v_perm_b32 v39, v103, v99, s77
    v_mfma_f32_16x16x32_bf16 v[40:43], v[140:143], v[8:11], 0
    v_mfma_f32_16x16x32_bf16 v[44:47], v[140:143], v[12:15], 0
    v_mfma_f32_16x16x32_bf16 v[48:51], v[140:143], v[16:19], 0
    v_mfma_f32_16x16x32_bf16 v[52:55], v[140:143], v[20:23], 0
    v_mfma_f32_16x16x32_bf16 v[56:59], v[140:143], v[24:27], 0
    v_mfma_f32_16x16x32_bf16 v[60:63], v[140:143], v[28:31], 0
    v_mfma_f32_16x16x32_bf16 v[64:67], v[140:143], v[32:35], 0
    v_mfma_f32_16x16x32_bf16 v[68:71], v[140:143], v[36:39], 0
    v_and_b32 v154, 31, v0
    v_lshrrev_b32 v155, 5, v0
    s_cmp_ge_u32 s3, 4
    s_cbranch_scc1 L_pre_hi
    v_and_b32 v156, 3, v154
    v_mul_u32_u24 v156, 544, v156
    v_lshrrev_b32 v157, 2, v154
    v_lshl_add_u32 v157, v155, 3, v157
    s_lshl_b32 s4, s3, 4
    v_add_u32 v157, s4, v157
    v_lshl_add_u32 v156, v157, 2, v156
    s_lshl_b32 s4, s3, 6
    v_mov_b32 v157, s4
    v_lshlrev_b32 v158, 13, v155
    v_lshl_add_u32 v158, v154, 3, v158
    s_lshl_b32 s4, s92, 2
    s_add_u32 s4, s4, s3
    s_lshl_b32 s8, s4, 14
    s_lshl_b32 s4, s93, 11
    s_add_u32 s8, s8, s4
    s_lshl_b32 s4, s94, 8
    s_add_u32 s8, s8, s4
    s_add_u32 s8, s8, 0x200000
    v_mov_b32 v163, s42
    s_branch L_pre_done
L_pre_hi:
    v_and_b32 v159, 3, v0
    v_lshl_add_u32 v159, v7, 2, v159
    v_bfe_u32 v158, v0, 2, 2
    v_lshlrev_b32 v158, 8, v158
    v_lshl_add_u32 v158, v159, 4, v158
    s_lshl_b32 s8, s95, 13
    s_sub_u32 s4, s3, 4
    s_lshl_b32 s10, s4, 11
    s_add_u32 s8, s8, s10
    s_add_u32 s8, s8, 0x200000
    s_lshl_b32 s4, s4, 7
    v_lshl_add_u32 v156, v159, 3, s4
L_pre_done:
    s_waitcnt vmcnt(6)
    v_perm_b32 v72, v108, v104, s76
    v_perm_b32 v76, v108, v104, s77
    v_perm_b32 v80, v109, v105, s76
    v_perm_b32 v84, v109, v105, s77
    v_perm_b32 v88, v110, v106, s76
    v_perm_b32 v92, v110, v106, s77
    v_perm_b32 v96, v111, v107, s76
    v_perm_b32 v100, v111, v107, s77
    s_waitcnt vmcnt(4)
    v_perm_b32 v73, v116, v112, s76
    v_perm_b32 v77, v116, v112, s77
    v_perm_b32 v81, v117, v113, s76
    v_perm_b32 v85, v117, v113, s77
    v_perm_b32 v89, v118, v114, s76
    v_perm_b32 v93, v118, v114, s77
    v_perm_b32 v97, v119, v115, s76
    v_perm_b32 v101, v119, v115, s77
    s_waitcnt vmcnt(2)
    v_perm_b32 v74, v124, v120, s76
    v_perm_b32 v78, v124, v120, s77
    v_perm_b32 v82, v125, v121, s76
    v_perm_b32 v86, v125, v121, s77
    v_perm_b32 v90, v126, v122, s76
    v_perm_b32 v94, v126, v122, s77
    v_perm_b32 v98, v127, v123, s76
    v_perm_b32 v102, v127, v123, s77
    s_waitcnt vmcnt(0)
    v_perm_b32 v75, v132, v128, s76
    v_perm_b32 v79, v132, v128, s77
    v_perm_b32 v83, v133, v129, s76
    v_perm_b32 v87, v133, v129, s77
    v_perm_b32 v91, v134, v130, s76
    v_perm_b32 v95, v134, v130, s77
    v_perm_b32 v99, v135, v131, s76
    v_perm_b32 v103, v135, v131, s77
    v_mfma_f32_16x16x32_bf16 v[40:43], v[144:147], v[72:75], v[40:43]
    v_mfma_f32_16x16x32_bf16 v[44:47], v[144:147], v[76:79], v[44:47]
    v_mfma_f32_16x16x32_bf16 v[48:51], v[144:147], v[80:83], v[48:51]
    v_mfma_f32_16x16x32_bf16 v[52:55], v[144:147], v[84:87], v[52:55]
    v_mfma_f32_16x16x32_bf16 v[56:59], v[144:147], v[88:91], v[56:59]
    v_mfma_f32_16x16x32_bf16 v[60:63], v[144:147], v[92:95], v[60:63]
    v_mfma_f32_16x16x32_bf16 v[64:67], v[144:147], v[96:99], v[64:67]
    v_mfma_f32_16x16x32_bf16 v[68:71], v[144:147], v[100:103], v[68:71]
    s_nop 0
    ds_write_b32 v152, v40 offset:4352
    ds_write_b32 v152, v44 offset:4624
    ds_write_b32 v152, v48 offset:4896
    ds_write_b32 v152, v52 offset:5168
    ds_write_b32 v152, v56 offset:5440
    ds_write_b32 v152, v60 offset:5712
    ds_write_b32 v152, v64 offset:5984
    ds_write_b32 v152, v68 offset:6256
    s_waitcnt lgkmcnt(0)
    s_mov_b64 exec, 1
    ds_add_u32 v5, v6 offset:4
    s_mov_b64 exec, -1
    s_cmp_ge_u32 s3, 4
    s_cbranch_scc1 L_poller
    s_mov_b32 s5, 0
L_spin2:
    ds_read_b32 v4, v5 offset:28
    s_waitcnt lgkmcnt(0)
    v_readfirstlane_b32 s4, v4
    s_cmp_ge_u32 s4, 8
    s_cbranch_scc1 L_spin2_done
    s_add_u32 s5, s5, 1
    s_cmp_lt_u32 s5, 8000000
    s_cbranch_scc1 L_spin2
L_spin2_done:
    ds_read_b128 v[16:19], v157 offset:1280
    ds_read_b128 v[20:23], v157 offset:1296
    ds_read_b128 v[24:27], v157 offset:1312
    ds_read_b128 v[28:31], v157 offset:1328
    s_waitcnt lgkmcnt(0)
    v_max3_f32 v48, v16, v18, v20
    v_max3_f32 v49, v22, v24, v26
    v_max3_f32 v48, v48, v28, v30
    v_max_f32 v48, v48, v49
    v_mul_f32 v49, s80, v48
    v_fma_f32 v16, v16, s78, v49
    v_fma_f32 v18, v18, s78, v49
    v_fma_f32 v20, v20, s78, v49
    v_fma_f32 v22, v22, s78, v49
    v_fma_f32 v24, v24, s78, v49
    v_fma_f32 v26, v26, s78, v49
    v_fma_f32 v28, v28, s78, v49
    v_fma_f32 v30, v30, s78, v49
    v_exp_f32 v16, v16
    v_exp_f32 v18, v18
    v_exp_f32 v20, v20
    v_exp_f32 v22, v22
    v_exp_f32 v24, v24
    v_exp_f32 v26, v26
    v_exp_f32 v28, v28
    v_exp_f32 v30, v30
    v_mul_f32 v50, v16, v17
    v_fmac_f32 v50, v18, v19
    v_fmac_f32 v50, v20, v21
    v_fmac_f32 v50, v22, v23
    v_fmac_f32 v50, v24, v25
    v_fmac_f32 v50, v26, v27
    v_fmac_f32 v50, v28, v29
    v_fmac_f32 v50, v30, v31
    v_rcp_f32 v53, v50
    v_log_f32 v54, v50
    v_mul_f32 v16, v16, v53
    v_mul_f32 v18, v18, v53
    v_mul_f32 v20, v20, v53
    v_mul_f32 v22, v22, v53
    v_mul_f32 v24, v24, v53
    v_mul_f32 v26, v26, v53
    v_mul_f32 v28, v28, v53
    v_mul_f32 v30, v30, v53
    v_sub_f32 v162, v54, v49
    v_add_u32 v162, 0x80, v162
    v_and_b32 v162, 0xffffff00, v162
    v_or_b32 v162, s75, v162
    s_mov_b32 s5, 0
L_spin3:
    ds_read_b32 v4, v5 offset:4
    s_waitcnt lgkmcnt(0)
    v_readfirstlane_b32 s4, v4
    s_cmp_ge_u32 s4, 11
    s_cbranch_scc1 L_spin3_done
    s_add_u32 s5, s5, 1
    s_cmp_lt_u32 s5, 8000000
    s_cbranch_scc1 L_spin3
L_spin3_done:
    ds_read_b32 v32, v156 offset:4352
    ds_read_b32 v33, v156 offset:4624
    ds_read_b32 v34, v156 offset:6528
    ds_read_b32 v35, v156 offset:6800
    ds_read_b32 v36, v156 offset:8704
    ds_read_b32 v37, v156 offset:8976
    ds_read_b32 v38, v156 offset:10880
    ds_read_b32 v39, v156 offset:11152
    ds_read_b32 v40, v156 offset:13056
    ds_read_b32 v41, v156 offset:13328
    ds_read_b32 v42, v156 offset:15232
    ds_read_b32 v43, v156 offset:15504
    ds_read_b32 v44, v156 offset:17408
    ds_read_b32 v45, v156 offset:17680
    ds_read_b32 v46, v156 offset:19584
    ds_read_b32 v47, v156 offset:19856
    s_waitcnt lgkmcnt(12)
    v_mul_f32 v51, v16, v32
    v_mul_f32 v52, v16, v33
    v_mul_f32 v53, v18, v34
    v_mul_f32 v54, v18, v35
    s_waitcnt lgkmcnt(8)
    v_fmac_f32 v51, v20, v36
    v_fmac_f32 v52, v20, v37
    v_fmac_f32 v53, v22, v38
    v_fmac_f32 v54, v22, v39
    s_waitcnt lgkmcnt(4)
    v_fmac_f32 v51, v24, v40
    v_fmac_f32 v52, v24, v41
    v_fmac_f32 v53, v26, v42
    v_fmac_f32 v54, v26, v43
    s_waitcnt lgkmcnt(0)
    v_fmac_f32 v51, v28, v44
    v_fmac_f32 v52, v28, v45
    v_fmac_f32 v53, v30, v46
    v_fmac_f32 v54, v30, v47
    v_add_f32 v51, v51, v53
    v_add_f32 v52, v52, v54
    v_cvt_pk_bf16_f32 v160, v51, v52
    s_nop 1
    v_mov_b32_dpp v161, v160 quad_perm:[1,1,3,3] row_mask:0xf bank_mask:0xf
    s_mov_b32 exec_lo, 0x55555555
    s_mov_b32 exec_hi, 0x55555555
    buffer_store_dwordx4 v[160:163], v158, s[56:59], s8 offen sc1
    s_mov_b64 exec, -1
    s_endpgm
L_poller:
    s_mov_b32 s9, 0
    buffer_load_dwordx4 v[8:11], v158, s[56:59], s8 offen offset:0 sc1
    buffer_load_dwordx4 v[12:15], v158, s[56:59], s8 offen offset:1024 sc1
L_ap:
    s_waitcnt vmcnt(0)
    v_and_b32 v16, 0xff, v10
    v_cmp_ne_u32 s[16:17], s42, v11
    v_cmp_ne_u32 vcc, s75, v16
    s_or_b64 s[16:17], s[16:17], vcc
    v_and_b32 v17, 0xff, v14
    v_cmp_ne_u32 s[18:19], s42, v15
    v_cmp_ne_u32 vcc, s75, v17
    s_or_b64 s[18:19], s[18:19], vcc
    s_or_b64 s[6:7], s[16:17], s[18:19]
    s_cmp_eq_u64 s[6:7], 0
    s_cbranch_scc1 L_ap_done
    s_add_u32 s9, s9, 1
    s_cmp_ge_u32 s9, 2000000
    s_cbranch_scc1 L_ap_done
    s_sleep 1
    s_mov_b64 exec, s[16:17]
    s_cbranch_execz L_ap_sk0
    buffer_load_dwordx4 v[8:11], v158, s[56:59], s8 offen offset:0 sc1
L_ap_sk0:
    s_mov_b64 exec, s[18:19]
    s_cbranch_execz L_ap_sk1
    buffer_load_dwordx4 v[12:15], v158, s[56:59], s8 offen offset:1024 sc1
L_ap_sk1:
    s_mov_b64 exec, -1
    s_branch L_ap
L_ap_done:
    v_and_b32 v10, 0xffffff00, v10
    v_and_b32 v14, 0xffffff00, v14
    v_max_f32 v24, v10, v14
    v_lshlrev_b32 v32, 16, v8
    v_and_b32 v33, s81, v8
    v_max_f32_dpp v24, v24, v24 row_ror:4 row_mask:0xf bank_mask:0xf
    v_lshlrev_b32 v34, 16, v9
    v_and_b32 v35, s81, v9
    v_max_f32_dpp v24, v24, v24 row_ror:8 row_mask:0xf bank_mask:0xf
    v_lshlrev_b32 v36, 16, v12
    v_and_b32 v37, s81, v12
    v_sub_f32 v10, v10, v24
    v_sub_f32 v14, v14, v24
    v_exp_f32 v10, v10
    v_exp_f32 v14, v14
    v_lshlrev_b32 v38, 16, v13
    v_and_b32 v39, s81, v13
    v_add_f32 v26, v10, v14
    v_mul_f32 v27, v10, v32
    v_mul_f32 v28, v10, v33
    v_mul_f32 v29, v10, v34
    v_mul_f32 v30, v10, v35
    v_fmac_f32 v27, v14, v36
    v_fmac_f32 v28, v14, v37
    v_fmac_f32 v29, v14, v38
    v_fmac_f32 v30, v14, v39
    v_add_f32_dpp v26, v26, v26 row_ror:4 row_mask:0xf bank_mask:0xf
    v_add_f32_dpp v27, v27, v27 row_ror:4 row_mask:0xf bank_mask:0xf
    v_add_f32_dpp v28, v28, v28 row_ror:4 row_mask:0xf bank_mask:0xf
    v_add_f32_dpp v29, v29, v29 row_ror:4 row_mask:0xf bank_mask:0xf
    v_add_f32_dpp v30, v30, v30 row_ror:4 row_mask:0xf bank_mask:0xf
    v_add_f32_dpp v26, v26, v26 row_ror:8 row_mask:0xf bank_mask:0xf
    v_add_f32_dpp v27, v27, v27 row_ror:8 row_mask:0xf bank_mask:0xf
    v_add_f32_dpp v28, v28, v28 row_ror:8 row_mask:0xf bank_mask:0xf
    v_add_f32_dpp v29, v29, v29 row_ror:8 row_mask:0xf bank_mask:0xf
    v_add_f32_dpp v30, v30, v30 row_ror:8 row_mask:0xf bank_mask:0xf
    v_rcp_f32 v26, v26
    s_nop 0
    v_mul_f32 v27, v27, v26
    v_mul_f32 v28, v28, v26
    v_mul_f32 v29, v29, v26
    v_mul_f32 v30, v30, v26
    v_cvt_pk_bf16_f32 v32, v27, v28
    v_cvt_pk_bf16_f32 v33, v29, v30
    ds_write_b64 v156, v[32:33] offset:1792
    s_waitcnt lgkmcnt(0)
    s_mov_b64 exec, 1
    ds_add_u32 v5, v6 offset:16
    s_mov_b64 exec, -1
    s_endpgm
L_helper:
    s_barrier
    s_setprio 3
    s_mov_b32 s73, 0xfffffc00
    s_cmp_lg_u32 s3, 11
    s_cbranch_scc1 L_nocpf
    s_getpc_b64 s[100:101]
L_pcbase:
    s_and_b32 s100, s100, 0xffffff00
    s_sub_u32 s100, s100, 0x1100
    s_subb_u32 s101, s101, 0
    s_lshr_b32 s4, s2, 3
    s_and_b32 s4, s4, 7
    s_lshl_b32 s4, s4, 12
    v_lshl_add_u32 v2, v0, 6, s4
    v_cmp_gt_u32 vcc, 0x29f0, v2
    s_and_saveexec_b64 s[6:7], vcc
    s_cbranch_execz L_cpf_x
    global_load_dword v160, v2, s[100:101]
L_cpf_x:
    s_mov_b64 exec, -1
L_nocpf:
    s_mov_b32 s48, s16
    s_mov_b32 s49, s17
    s_mov_b32 s50, 0x1000
    s_mov_b32 s51, 0x20000
    s_sub_u32 s10, s3, 8
    s_cmp_ge_u32 s2, 240
    s_cbranch_scc1 L_s1_skip
    s_lshr_b32 s97, s2, 4
    s_lshl_b32 s97, s97, 3
    s_add_u32 s97, s97, s94
    s_bfe_u32 s83, s2, 0x10003
    s_mov_b32 s44, s22
    s_mov_b32 s45, s23
    s_mov_b32 s46, 0x400000
    s_mov_b32 s98, 8192
    s_lshl_b32 s11, s97, 7
    s_cmp_lt_u32 s2, 128
    s_cbranch_scc1 L_s1_sel
    s_mov_b32 s44, s28
    s_mov_b32 s45, s29
    s_mov_b32 s46, 0x1c0000
    s_mov_b32 s98, 3584
    s_sub_u32 s4, s97, 64
    s_lshl_b32 s11, s4, 7
    s_cmp_lt_u32 s97, 92
    s_cbranch_scc1 L_s1_sel
    s_mov_b32 s44, s30
    s_mov_b32 s45, s31
    s_sub_u32 s4, s97, 92
    s_lshl_b32 s11, s4, 7
L_s1_sel:
    s_mov_b32 s47, 0x20000
    v_lshrrev_b32 v2, 2, v1
    v_lshlrev_b32 v2, 10, v2
    s_lshl_b32 s82, s83, 2
    s_add_u32 s82, s82, s10
    s_cmp_lg_u32 s10, 0
    s_cbranch_scc1 L_s1_nox
    v_and_b32 v34, 3, v0
    v_lshl_add_u32 v34, v7, 2, v34
    v_lshl_add_u32 v34, v34, 6, v2
    buffer_load_dwordx4 v[8:11], v34, s[48:51], 0 offen offset:0
    buffer_load_dwordx4 v[12:15], v34, s[48:51], 0 offen offset:16
    buffer_load_dwordx4 v[16:19], v34, s[48:51], 0 offen offset:32
    buffer_load_dwordx4 v[20:23], v34, s[48:51], 0 offen offset:48
L_s1_nox:
    s_lshl_b32 s4, s98, 3
    v_mul_lo_u32 v3, v7, s4
    v_lshl_add_u32 v3, v1, 3, v3
    s_lshl_b32 s4, s98, 6
    s_mul_i32 s8, s82, s4
    s_add_u32 s8, s8, s11
    s_mul_i32 s99, s98, 25
    buffer_load_dwordx2 v[40:41], v3, s[44:47], s8 offen nt
    s_add_u32 s8, s8, s98
    buffer_load_dwordx2 v[42:43], v3, s[44:47], s8 offen nt
    s_add_u32 s8, s8, s98
    buffer_load_dwordx2 v[44:45], v3, s[44:47], s8 offen nt
    s_add_u32 s8, s8, s98
    buffer_load_dwordx2 v[46:47], v3, s[44:47], s8 offen nt
    s_add_u32 s8, s8, s98
    buffer_load_dwordx2 v[48:49], v3, s[44:47], s8 offen nt
    s_add_u32 s8, s8, s98
    buffer_load_dwordx2 v[50:51], v3, s[44:47], s8 offen nt
    s_add_u32 s8, s8, s98
    buffer_load_dwordx2 v[52:53], v3, s[44:47], s8 offen nt
    s_add_u32 s8, s8, s98
    buffer_load_dwordx2 v[54:55], v3, s[44:47], s8 offen nt
    s_add_u32 s8, s8, s99
    buffer_load_dwordx2 v[56:57], v3, s[44:47], s8 offen nt
    s_add_u32 s8, s8, s98
    buffer_load_dwordx2 v[58:59], v3, s[44:47], s8 offen nt
    s_add_u32 s8, s8, s98
    buffer_load_dwordx2 v[60:61], v3, s[44:47], s8 offen nt
    s_add_u32 s8, s8, s98
    buffer_load_dwordx2 v[62:63], v3, s[44:47], s8 offen nt
    s_add_u32 s8, s8, s98
    buffer_load_dwordx2 v[64:65], v3, s[44:47], s8 offen nt
    s_add_u32 s8, s8, s98
    buffer_load_dwordx2 v[66:67], v3, s[44:47], s8 offen nt
    s_add_u32 s8, s8, s98
    buffer_load_dwordx2 v[68:69], v3, s[44:47], s8 offen nt
    s_add_u32 s8, s8, s98
    buffer_load_dwordx2 v[70:71], v3, s[44:47], s8 offen nt
    v_lshl_add_u32 v35, v7, 4, v2
    s_lshl_b32 s4, s82, 7
    v_add_u32 v35, s4, v35
    s_cmp_lg_u32 s10, 0
    s_cbranch_scc1 L_s1_wxn
    s_waitcnt vmcnt(16)
    v_lshlrev_b32 v104, 16, v8
    v_and_b32 v105, s81, v8
    v_lshlrev_b32 v106, 16, v9
    v_and_b32 v107, s81, v9
    v_lshlrev_b32 v108, 16, v10
    v_and_b32 v109, s81, v10
    v_lshlrev_b32 v110, 16, v11
    v_and_b32 v111, s81, v11
    v_lshlrev_b32 v112, 16, v12
    v_and_b32 v113, s81, v12
    v_lshlrev_b32 v114, 16, v13
    v_and_b32 v115, s81, v13
    v_lshlrev_b32 v116, 16, v14
    v_and_b32 v117, s81, v14
    v_lshlrev_b32 v118, 16, v15
    v_and_b32 v119, s81, v15
    v_lshlrev_b32 v120, 16, v16
    v_and_b32 v121, s81, v16
    v_lshlrev_b32 v122, 16, v17
    v_and_b32 v123, s81, v17
    v_lshlrev_b32 v124, 16, v18
    v_and_b32 v125, s81, v18
    v_lshlrev_b32 v126, 16, v19
    v_and_b32 v127, s81, v19
    v_lshlrev_b32 v128, 16, v20
    v_and_b32 v129, s81, v20
    v_lshlrev_b32 v130, 16, v21
    v_and_b32 v131, s81, v21
    v_lshlrev_b32 v132, 16, v22
    v_and_b32 v133, s81, v22
    v_lshlrev_b32 v134, 16, v23
    v_and_b32 v135, s81, v23
    v_add_f32 v24, v104, v108
    v_add_f32 v25, v105, v109
    v_add_f32 v26, v106, v110
    v_add_f32 v27, v107, v111
    v_add_f32 v24, v24, v112
    v_add_f32 v25, v25, v113
    v_add_f32 v26, v26, v114
    v_add_f32 v27, v27, v115
    v_add_f32 v24, v24, v116
    v_add_f32 v25, v25, v117
    v_add_f32 v26, v26, v118
    v_add_f32 v27, v27, v119
    v_add_f32 v24, v24, v120
    v_add_f32 v25, v25, v121
    v_add_f32 v26, v26, v122
    v_add_f32 v27, v27, v123
    v_add_f32 v24, v24, v124
    v_add_f32 v25, v25, v125
    v_add_f32 v26, v26, v126
    v_add_f32 v27, v27, v127
    v_add_f32 v24, v24, v128
    v_add_f32 v25, v25, v129
    v_add_f32 v26, v26, v130
    v_add_f32 v27, v27, v131
    v_add_f32 v24, v24, v132
    v_add_f32 v25, v25, v133
    v_add_f32 v26, v26, v134
    v_add_f32 v27, v27, v135
    v_add_f32 v24, v24, v25
    v_add_f32 v26, v26, v27
    v_add_f32 v24, v24, v26
    s_nop 1
    v_add_f32_dpp v24, v24, v24 quad_perm:[1,0,3,2] row_mask:0xf bank_mask:0xf
    s_nop 1
    v_add_f32_dpp v24, v24, v24 quad_perm:[2,3,0,1] row_mask:0xf bank_mask:0xf
    v_mov_b32 v28, v24
    s_nop 1
    v_permlane16_swap_b32 v24, v28
    v_add_f32 v24, v24, v28
    v_mov_b32 v28, v24
    s_nop 1
    v_permlane32_swap_b32 v24, v28
    v_add_f32 v24, v24, v28
    v_mul_f32 v29, 0x3b000000, v24
    v_sub_f32 v72, v104, v29
    v_sub_f32 v73, v105, v29
    v_sub_f32 v74, v106, v29
    v_sub_f32 v75, v107, v29
    v_sub_f32 v76, v108, v29
    v_sub_f32 v77, v109, v29
    v_sub_f32 v78, v110, v29
    v_sub_f32 v79, v111, v29
    v_sub_f32 v80, v112, v29
    v_sub_f32 v81, v113, v29
    v_sub_f32 v82, v114, v29
    v_sub_f32 v83, v115, v29
    v_sub_f32 v84, v116, v29
    v_sub_f32 v85, v117, v29
    v_sub_f32 v86, v118, v29
    v_sub_f32 v87, v119, v29
    v_sub_f32 v88, v120, v29
    v_sub_f32 v89, v121, v29
    v_sub_f32 v90, v122, v29
    v_sub_f32 v91, v123, v29
    v_sub_f32 v92, v124, v29
    v_sub_f32 v93, v125, v29
    v_sub_f32 v94, v126, v29
    v_sub_f32 v95, v127, v29
    v_sub_f32 v96, v128, v29
    v_sub_f32 v97, v129, v29
    v_sub_f32 v98, v130, v29
    v_sub_f32 v99, v131, v29
    v_sub_f32 v100, v132, v29
    v_sub_f32 v101, v133, v29
    v_sub_f32 v102, v134, v29
    v_sub_f32 v103, v135, v29
    v_mul_f32 v24, v72, v72
    v_mul_f32 v25, v73, v73
    v_mul_f32 v26, v74, v74
    v_mul_f32 v27, v75, v75
    v_fmac_f32 v24, v76, v76
    v_fmac_f32 v25, v77, v77
    v_fmac_f32 v26, v78, v78
    v_fmac_f32 v27, v79, v79
    v_fmac_f32 v24, v80, v80
    v_fmac_f32 v25, v81, v81
    v_fmac_f32 v26, v82, v82
    v_fmac_f32 v27, v83, v83
    v_fmac_f32 v24, v84, v84
    v_fmac_f32 v25, v85, v85
    v_fmac_f32 v26, v86, v86
    v_fmac_f32 v27, v87, v87
    v_fmac_f32 v24, v88, v88
    v_fmac_f32 v25, v89, v89
    v_fmac_f32 v26, v90, v90
    v_fmac_f32 v27, v91, v91
    v_fmac_f32 v24, v92, v92
    v_fmac_f32 v25, v93, v93
    v_fmac_f32 v26, v94, v94
    v_fmac_f32 v27, v95, v95
    v_fmac_f32 v24, v96, v96
    v_fmac_f32 v25, v97, v97
    v_fmac_f32 v26, v98, v98
    v_fmac_f32 v27, v99, v99
    v_fmac_f32 v24, v100, v100
    v_fmac_f32 v25, v101, v101
    v_fmac_f32 v26, v102, v102
    v_fmac_f32 v27, v103, v103
    v_add_f32 v24, v24, v25
    v_add_f32 v26, v26, v27
    v_add_f32 v24, v24, v26
    s_nop 1
    v_add_f32_dpp v24, v24, v24 quad_perm:[1,0,3,2] row_mask:0xf bank_mask:0xf
    s_nop 1
    v_add_f32_dpp v24, v24, v24 quad_perm:[2,3,0,1] row_mask:0xf bank_mask:0xf
    v_mov_b32 v28, v24
    s_nop 1
    v_permlane16_swap_b32 v24, v28
    v_add_f32 v24, v24, v28
    v_mov_b32 v28, v24
    s_nop 1
    v_permlane32_swap_b32 v24, v28
    v_add_f32 v24, v24, v28
    v_mul_f32 v24, 0x3b000000, v24
    v_cvt_pk_bf16_f32 v24, v24, v24
    v_lshlrev_b32 v24, 16, v24
    v_cvt_pk_bf16_f32 v29, v29, v29
    v_lshlrev_b32 v29, 16, v29
    v_add_f32 v24, 0x3727c5ac, v24
    v_cvt_pk_bf16_f32 v24, v24, v24
    v_lshlrev_b32 v24, 16, v24
    v_sqrt_f32 v24, v24
    s_nop 0
    v_cvt_pk_bf16_f32 v24, v24, v24
    v_lshlrev_b32 v24, 16, v24
    v_rcp_f32 v30, v24
    v_sub_f32 v104, v104, v29
    v_sub_f32 v105, v105, v29
    v_sub_f32 v106, v106, v29
    v_sub_f32 v107, v107, v29
    v_sub_f32 v108, v108, v29
    v_sub_f32 v109, v109, v29
    v_sub_f32 v110, v110, v29
    v_sub_f32 v111, v111, v29
    v_sub_f32 v112, v112, v29
    v_sub_f32 v113, v113, v29
    v_sub_f32 v114, v114, v29
    v_sub_f32 v115, v115, v29
    v_sub_f32 v116, v116, v29
    v_sub_f32 v117, v117, v29
    v_sub_f32 v118, v118, v29
    v_sub_f32 v119, v119, v29
    v_sub_f32 v120, v120, v29
    v_sub_f32 v121, v121, v29
    v_sub_f32 v122, v122, v29
    v_sub_f32 v123, v123, v29
    v_sub_f32 v124, v124, v29
    v_sub_f32 v125, v125, v29
    v_sub_f32 v126, v126, v29
    v_sub_f32 v127, v127, v29
    v_sub_f32 v128, v128, v29
    v_sub_f32 v129, v129, v29
    v_sub_f32 v130, v130, v29
    v_sub_f32 v131, v131, v29
    v_sub_f32 v132, v132, v29
    v_sub_f32 v133, v133, v29
    v_sub_f32 v134, v134, v29
    v_sub_f32 v135, v135, v29
    v_cvt_pk_bf16_f32 v8, v104, v105
    v_cvt_pk_bf16_f32 v9, v106, v107
    v_cvt_pk_bf16_f32 v10, v108, v109
    v_cvt_pk_bf16_f32 v11, v110, v111
    v_cvt_pk_bf16_f32 v12, v112, v113
    v_cvt_pk_bf16_f32 v13, v114, v115
    v_cvt_pk_bf16_f32 v14, v116, v117
    v_cvt_pk_bf16_f32 v15, v118, v119
    v_cvt_pk_bf16_f32 v16, v120, v121
    v_cvt_pk_bf16_f32 v17, v122, v123
    v_cvt_pk_bf16_f32 v18, v124, v125
    v_cvt_pk_bf16_f32 v19, v126, v127
    v_cvt_pk_bf16_f32 v20, v128, v129
    v_cvt_pk_bf16_f32 v21, v130, v131
    v_cvt_pk_bf16_f32 v22, v132, v133
    v_cvt_pk_bf16_f32 v23, v134, v135
    v_lshlrev_b32 v104, 16, v8
    v_and_b32 v105, s81, v8
    v_lshlrev_b32 v106, 16, v9
    v_and_b32 v107, s81, v9
    v_lshlrev_b32 v108, 16, v10
    v_and_b32 v109, s81, v10
    v_lshlrev_b32 v110, 16, v11
    v_and_b32 v111, s81, v11
    v_lshlrev_b32 v112, 16, v12
    v_and_b32 v113, s81, v12
    v_lshlrev_b32 v114, 16, v13
    v_and_b32 v115, s81, v13
    v_lshlrev_b32 v116, 16, v14
    v_and_b32 v117, s81, v14
    v_lshlrev_b32 v118, 16, v15
    v_and_b32 v119, s81, v15
    v_lshlrev_b32 v120, 16, v16
    v_and_b32 v121, s81, v16
    v_lshlrev_b32 v122, 16, v17
    v_and_b32 v123, s81, v17
    v_lshlrev_b32 v124, 16, v18
    v_and_b32 v125, s81, v18
    v_lshlrev_b32 v126, 16, v19
    v_and_b32 v127, s81, v19
    v_lshlrev_b32 v128, 16, v20
    v_and_b32 v129, s81, v20
    v_lshlrev_b32 v130, 16, v21
    v_and_b32 v131, s81, v21
    v_lshlrev_b32 v132, 16, v22
    v_and_b32 v133, s81, v22
    v_lshlrev_b32 v134, 16, v23
    v_and_b32 v135, s81, v23
    v_mul_f32 v104, v104, v30
    v_mul_f32 v105, v105, v30
    v_mul_f32 v106, v106, v30
    v_mul_f32 v107, v107, v30
    v_mul_f32 v108, v108, v30
    v_mul_f32 v109, v109, v30
    v_mul_f32 v110, v110, v30
    v_mul_f32 v111, v111, v30
    v_mul_f32 v112, v112, v30
    v_mul_f32 v113, v113, v30
    v_mul_f32 v114, v114, v30
    v_mul_f32 v115, v115, v30
    v_mul_f32 v116, v116, v30
    v_mul_f32 v117, v117, v30
    v_mul_f32 v118, v118, v30
    v_mul_f32 v119, v119, v30
    v_mul_f32 v120, v120, v30
    v_mul_f32 v121, v121, v30
    v_mul_f32 v122, v122, v30
    v_mul_f32 v123, v123, v30
    v_mul_f32 v124, v124, v30
    v_mul_f32 v125, v125, v30
    v_mul_f32 v126, v126, v30
    v_mul_f32 v127, v127, v30
    v_mul_f32 v128, v128, v30
    v_mul_f32 v129, v129, v30
    v_mul_f32 v130, v130, v30
    v_mul_f32 v131, v131, v30
    v_mul_f32 v132, v132, v30
    v_mul_f32 v133, v133, v30
    v_mul_f32 v134, v134, v30
    v_mul_f32 v135, v135, v30
    v_cvt_pk_bf16_f32 v8, v104, v105
    v_cvt_pk_bf16_f32 v9, v106, v107
    v_cvt_pk_bf16_f32 v10, v108, v109
    v_cvt_pk_bf16_f32 v11, v110, v111
    v_cvt_pk_bf16_f32 v12, v112, v113
    v_cvt_pk_bf16_f32 v13, v114, v115
    v_cvt_pk_bf16_f32 v14, v116, v117
    v_cvt_pk_bf16_f32 v15, v118, v119
    v_cvt_pk_bf16_f32 v16, v120, v121
    v_cvt_pk_bf16_f32 v17, v122, v123
    v_cvt_pk_bf16_f32 v18, v124, v125
    v_cvt_pk_bf16_f32 v19, v126, v127
    v_cvt_pk_bf16_f32 v20, v128, v129
    v_cvt_pk_bf16_f32 v21, v130, v131
    v_cvt_pk_bf16_f32 v22, v132, v133
    v_cvt_pk_bf16_f32 v23, v134, v135
    ds_write_b128 v34, v[8:11] offset:24832
    ds_write_b128 v34, v[12:15] offset:24848
    ds_write_b128 v34, v[16:19] offset:24864
    ds_write_b128 v34, v[20:23] offset:24880
    s_waitcnt lgkmcnt(0)
    s_mov_b64 exec, 1
    ds_add_u32 v5, v6 offset:24
    s_mov_b64 exec, -1
    s_branch L_s1_xn
L_s1_wxn:
    s_mov_b32 s5, 0
L_spin4:
    ds_read_b32 v4, v5 offset:24
    s_waitcnt lgkmcnt(0)
    v_readfirstlane_b32 s4, v4
    s_cmp_ge_u32 s4, 1
    s_cbranch_scc1 L_spin4_done
    s_sleep 1
    s_add_u32 s5, s5, 1
    s_cmp_lt_u32 s5, 8000000
    s_cbranch_scc1 L_spin4
L_spin4_done:
L_s1_xn:
    ds_read_b128 v[24:27], v35 offset:24832
    ds_read_b128 v[28:31], v35 offset:24896
    s_waitcnt lgkmcnt(0)
    s_waitcnt vmcnt(8)
    v_perm_b32 v104, v42, v40, s76
    v_perm_b32 v108, v42, v40, s77
    v_perm_b32 v112, v43, v41, s76
    v_perm_b32 v116, v43, v41, s77
    v_perm_b32 v105, v46, v44, s76
    v_perm_b32 v109, v46, v44, s77
    v_perm_b32 v113, v47, v45, s76
    v_perm_b32 v117, v47, v45, s77
    v_perm_b32 v106, v50, v48, s76
    v_perm_b32 v110, v50, v48, s77
    v_perm_b32 v114, v51, v49, s76
    v_perm_b32 v118, v51, v49, s77
    v_perm_b32 v107, v54, v52, s76
    v_perm_b32 v111, v54, v52, s77
    v_perm_b32 v115, v55, v53, s76
    v_perm_b32 v119, v55, v53, s77
    v_mfma_f32_16x16x32_bf16 v[120:123], v[24:27], v[104:107], 0
    v_mfma_f32_16x16x32_bf16 v[124:127], v[24:27], v[108:111], 0
    v_mfma_f32_16x16x32_bf16 v[128:131], v[24:27], v[112:115], 0
    v_mfma_f32_16x16x32_bf16 v[132:135], v[24:27], v[116:119], 0
    s_waitcnt vmcnt(0)
    v_perm_b32 v104, v58, v56, s76
    v_perm_b32 v108, v58, v56, s77
    v_perm_b32 v112, v59, v57, s76
    v_perm_b32 v116, v59, v57, s77
    v_perm_b32 v105, v62, v60, s76
    v_perm_b32 v109, v62, v60, s77
    v_perm_b32 v113, v63, v61, s76
    v_perm_b32 v117, v63, v61, s77
    v_perm_b32 v106, v66, v64, s76
    v_perm_b32 v110, v66, v64, s77
    v_perm_b32 v114, v67, v65, s76
    v_perm_b32 v118, v67, v65, s77
    v_perm_b32 v107, v70, v68, s76
    v_perm_b32 v111, v70, v68, s77
    v_perm_b32 v115, v71, v69, s76
    v_perm_b32 v119, v71, v69, s77
    v_mfma_f32_16x16x32_bf16 v[120:123], v[28:31], v[104:107], v[120:123]
    v_mfma_f32_16x16x32_bf16 v[124:127], v[28:31], v[108:111], v[124:127]
    v_mfma_f32_16x16x32_bf16 v[128:131], v[28:31], v[112:115], v[128:131]
    v_mfma_f32_16x16x32_bf16 v[132:135], v[28:31], v[116:119], v[132:135]
    v_lshlrev_b32 v2, 4, v0
    s_nop 3
    v_mov_b32 v8, v120
    v_mov_b32 v9, v124
    v_mov_b32 v10, v128
    v_mov_b32 v11, v132
    s_cmp_eq_u32 s10, 0
    s_cbranch_scc1 L_s1_red
    s_lshl_b32 s4, s10, 10
    v_add_u32 v2, s4, v2
    ds_write_b128 v2, v[8:11] offset:20736
    s_waitcnt lgkmcnt(0)
    s_mov_b64 exec, 1
    ds_add_u32 v5, v6 offset:20
    s_mov_b64 exec, -1
    s_branch L_s1_done
L_s1_red:
    s_waitcnt lgkmcnt(0)
    s_add_u32 s42, s40, 1
    s_addc_u32 s43, s41, 0
    s_and_b32 s75, s43, 0xff
    v_mov_b32 v26, s42
    v_mov_b32 v27, s43
    v_mov_b32 v30, s42
    v_mov_b32 v31, s43
    s_lshl_b32 s12, s97, 11
    s_add_u32 s12, s12, 0x100000
    s_lshl_b32 s14, s97, 10
    s_add_u32 s14, s14, 0x180000
    s_mov_b32 s5, 0
L_spin5:
    ds_read_b32 v4, v5 offset:20
    s_waitcnt lgkmcnt(0)
    v_readfirstlane_b32 s4, v4
    s_cmp_ge_u32 s4, 3
    s_cbranch_scc1 L_spin5_done
    s_add_u32 s5, s5, 1
    s_cmp_lt_u32 s5, 8000000
    s_cbranch_scc1 L_spin5
L_spin5_done:
    ds_read_b128 v[12:15], v2 offset:21760
    ds_read_b128 v[16:19], v2 offset:22784
    ds_read_b128 v[20:23], v2 offset:23808
    s_waitcnt lgkmcnt(0)
    v_add_f32 v8, v8, v12
    v_add_f32 v16, v16, v20
    v_add_f32 v9, v9, v13
    v_add_f32 v17, v17, v21
    v_add_f32 v10, v10, v14
    v_add_f32 v18, v18, v22
    v_add_f32 v11, v11, v15
    v_add_f32 v19, v19, v23
    s_cmp_eq_u32 s83, 0
    s_cbranch_scc1 L_s1_qfin
    v_add_f32 v24, v8, v16
    v_add_f32 v25, v9, v17
    v_add_f32 v28, v10, v18
    v_add_f32 v29, v11, v19
    buffer_store_dwordx4 v[24:27], v2, s[56:59], s12 offen sc1
    buffer_store_dwordx4 v[28:31], v2, s[56:59], s12 offen offset:1024 sc1
    s_branch L_s1_done
L_s1_qfin:
    v_add_f32 v8, v8, v16
    v_add_f32 v9, v9, v17
    v_add_f32 v10, v10, v18
    v_add_f32 v11, v11, v19
    s_sleep 40
    s_mov_b32 s9, 0
    buffer_load_dwordx4 v[40:43], v2, s[56:59], s12 offen offset:0 sc1
    buffer_load_dwordx4 v[44:47], v2, s[56:59], s12 offen offset:1024 sc1
L_xp:
    s_waitcnt vmcnt(0)
    v_cmp_ne_u64 s[16:17], v[42:43], s[42:43]
    v_cmp_ne_u64 s[18:19], v[46:47], s[42:43]
    s_or_b64 s[6:7], s[16:17], s[18:19]
    s_cmp_eq_u64 s[6:7], 0
    s_cbranch_scc1 L_xp_done
    s_add_u32 s9, s9, 1
    s_cmp_ge_u32 s9, 2000000
    s_cbranch_scc1 L_xp_done
    s_sleep 4
    s_mov_b64 exec, s[16:17]
    s_cbranch_execz L_xp_sk0
    buffer_load_dwordx4 v[40:43], v2, s[56:59], s12 offen offset:0 sc1
L_xp_sk0:
    s_mov_b64 exec, s[18:19]
    s_cbranch_execz L_xp_sk1
    buffer_load_dwordx4 v[44:47], v2, s[56:59], s12 offen offset:1024 sc1
L_xp_sk1:
    s_mov_b64 exec, -1
    s_branch L_xp
L_xp_done:
    v_add_f32 v8, v8, v40
    v_add_f32 v9, v9, v41
    v_add_f32 v10, v10, v44
    v_add_f32 v11, v11, v45
    v_cvt_pk_bf16_f32 v24, v8, v9
    v_cvt_pk_bf16_f32 v25, v10, v11
    buffer_store_dwordx4 v[24:27], v2, s[56:59], s14 offen sc1
    s_branch L_s1_done
L_s1_skip:
L_s1_done:
    s_waitcnt lgkmcnt(0)
    s_add_u32 s42, s40, 1
    s_addc_u32 s43, s41, 0
    s_and_b32 s75, s43, 0xff
    s_cmp_eq_u32 s3, 9
    s_cbranch_scc1 L_h1
    s_cmp_eq_u32 s3, 10
    s_cbranch_scc1 L_h2
    s_cmp_eq_u32 s3, 11
    s_cbranch_scc1 L_h3
    v_lshlrev_b32 v3, 10, v7
    v_lshl_add_u32 v3, v1, 4, v3
    s_lshl_b32 s12, s92, 13
    s_lshl_b32 s4, s93, 8
    s_add_u32 s12, s12, s4
    s_add_u32 s12, s12, 0x180000
    s_add_u32 s13, s12, 4096
    v_lshlrev_b32 v2, 7, v7
    v_lshl_add_u32 v2, v1, 3, v2
    s_mov_b32 s5, 0
L_spin6:
    ds_read_b32 v4, v5 offset:36
    s_waitcnt lgkmcnt(0)
    v_readfirstlane_b32 s4, v4
    s_cmp_ge_u32 s4, 8
    s_cbranch_scc1 L_spin6_done
    s_sleep 4
    s_add_u32 s5, s5, 1
    s_cmp_lt_u32 s5, 8000000
    s_cbranch_scc1 L_spin6
L_spin6_done:
    s_mov_b32 s9, 0
    buffer_load_dwordx4 v[40:43], v3, s[56:59], s12 offen sc1
    buffer_load_dwordx4 v[44:47], v3, s[56:59], s13 offen sc1
L_qp:
    s_waitcnt vmcnt(0)
    v_cmp_ne_u64 s[16:17], v[42:43], s[42:43]
    v_cmp_ne_u64 s[18:19], v[46:47], s[42:43]
    s_or_b64 s[6:7], s[16:17], s[18:19]
    s_cmp_eq_u64 s[6:7], 0
    s_cbranch_scc1 L_qp_done
    s_add_u32 s9, s9, 1
    s_cmp_ge_u32 s9, 2000000
    s_cbranch_scc1 L_qp_done
    s_sleep 4
    s_mov_b64 exec, s[16:17]
    s_cbranch_execz L_qp_sk0
    buffer_load_dwordx4 v[40:43], v3, s[56:59], s12 offen sc1
L_qp_sk0:
    s_mov_b64 exec, s[18:19]
    s_cbranch_execz L_qp_sk1
    buffer_load_dwordx4 v[44:47], v3, s[56:59], s13 offen sc1
L_qp_sk1:
    s_mov_b64 exec, -1
    s_branch L_qp
L_qp_done:
    ds_write_b64 v2, v[40:41] offset:256
    ds_write_b64 v2, v[44:45] offset:768
    s_waitcnt lgkmcnt(0)
    s_mov_b64 exec, 1
    ds_add_u32 v5, v6 offset:0
    s_mov_b64 exec, -1
    s_endpgm
L_h1:
    s_mov_b64 exec, 1
    ds_add_u32 v5, v6 offset:4
    s_mov_b64 exec, -1
    s_cmp_ge_u32 s95, 56
    s_cbranch_scc1 L_h1_none
    s_mov_b32 s52, s32
    s_mov_b32 s53, s33
    s_mov_b32 s54, 0x1c0000
    s_mov_b32 s55, 0x20000
    s_lshl_b32 s12, s95, 15
    s_lshl_b32 s4, s96, 8
    s_add_u32 s12, s12, s4
    s_add_u32 s13, s12, 4096
    v_lshrrev_b32 v4, 5, v0
    v_mul_u32_u24 v3, 28672, v4
    v_bfe_u32 v2, v0, 3, 2
    v_lshl_add_u32 v3, v2, 8, v3
    v_lshlrev_b32 v8, 6, v2
    v_and_b32 v2, 7, v0
    v_lshl_add_u32 v3, v2, 4, v3
    v_lshl_add_u32 v8, v2, 3, v8
    s_lshr_b32 s4, s95, 1
    s_lshl_b32 s84, s4, 10
    s_and_b32 s4, s95, 1
    s_lshl_b32 s4, s4, 7
    s_add_u32 s84, s84, s4
    s_add_u32 s84, s84, 0x190000
    s_mov_b32 s5, 0
L_spin7:
    ds_read_b32 v4, v5 offset:40
    s_waitcnt lgkmcnt(0)
    v_readfirstlane_b32 s4, v4
    s_cmp_ge_u32 s4, 8
    s_cbranch_scc1 L_spin7_done
    s_sleep 4
    s_add_u32 s5, s5, 1
    s_cmp_lt_u32 s5, 8000000
    s_cbranch_scc1 L_spin7
L_spin7_done:
    s_mov_b32 s9, 0
    buffer_load_dwordx4 v[40:43], v3, s[56:59], s84 offen sc1
L_gp:
    s_waitcnt vmcnt(0)
    v_cmp_ne_u64 s[16:17], v[42:43], s[42:43]
    s_mov_b64 s[6:7], s[16:17]
    s_cmp_eq_u64 s[6:7], 0
    s_cbranch_scc1 L_gp_done
    s_add_u32 s9, s9, 1
    s_cmp_ge_u32 s9, 2000000
    s_cbranch_scc1 L_gp_done
    s_sleep 8
    s_mov_b64 exec, s[16:17]
    s_cbranch_execz L_gp_sk0
    buffer_load_dwordx4 v[40:43], v3, s[56:59], s84 offen sc1
L_gp_sk0:
    s_mov_b64 exec, -1
    s_branch L_gp
L_gp_done:
    v_mov_b32 v44, v40
    v_mov_b32 v45, v41
    s_nop 0
    v_permlane32_swap_b32 v40, v44
    v_permlane32_swap_b32 v41, v45
    v_lshlrev_b32 v48, 16, v40
    v_and_b32 v49, s81, v40
    v_lshlrev_b32 v52, 16, v44
    v_and_b32 v53, s81, v44
    v_lshlrev_b32 v50, 16, v41
    v_and_b32 v51, s81, v41
    v_lshlrev_b32 v54, 16, v45
    v_and_b32 v55, s81, v45
    v_mul_f32 v56, s80, v48
    v_mul_f32 v57, s80, v49
    v_mul_f32 v58, s80, v50
    v_mul_f32 v59, s80, v51
    v_exp_f32 v56, v56
    v_exp_f32 v57, v57
    v_exp_f32 v58, v58
    v_exp_f32 v59, v59
    v_add_f32 v56, 1.0, v56
    v_add_f32 v57, 1.0, v57
    v_add_f32 v58, 1.0, v58
    v_add_f32 v59, 1.0, v59
    v_rcp_f32 v56, v56
    v_rcp_f32 v57, v57
    v_rcp_f32 v58, v58
    v_rcp_f32 v59, v59
    v_mul_f32 v56, v48, v56
    v_mul_f32 v57, v49, v57
    v_mul_f32 v58, v50, v58
    v_mul_f32 v59, v51, v59
    v_cvt_pk_bf16_f32 v40, v56, v57
    v_cvt_pk_bf16_f32 v41, v58, v59
    v_lshlrev_b32 v56, 16, v40
    v_and_b32 v57, s81, v40
    v_lshlrev_b32 v58, 16, v41
    v_and_b32 v59, s81, v41
    v_mul_f32 v56, v56, v52
    v_mul_f32 v57, v57, v53
    v_mul_f32 v58, v58, v54
    v_mul_f32 v59, v59, v55
    v_cvt_pk_bf16_f32 v40, v56, v57
    v_cvt_pk_bf16_f32 v41, v58, v59
    ds_write_b64 v8, v[40:41] offset:1536
    v_lshrrev_b32 v2, 2, v1
    v_lshlrev_b32 v2, 6, v2
    v_lshl_add_u32 v2, v7, 4, v2
    s_waitcnt lgkmcnt(0)
    ds_read_b128 v[72:75], v2 offset:1536
    s_mov_b32 s5, 0
L_spin8:
    ds_read_b32 v4, v5 offset:32
    s_waitcnt lgkmcnt(0)
    v_readfirstlane_b32 s4, v4
    s_cmp_ge_u32 s4, 1
    s_cbranch_scc1 L_spin8_done
    s_sleep 1
    s_add_u32 s5, s5, 1
    s_cmp_lt_u32 s5, 8000000
    s_cbranch_scc1 L_spin8
L_spin8_done:
    v_lshlrev_b32 v4, 13, v7
    v_lshl_add_u32 v4, v1, 4, v4
    buffer_load_dwordx4 v[136:139], v4, s[52:55], s12 offen offset:0 nt
    buffer_load_dwordx4 v[140:143], v4, s[52:55], s12 offen offset:1024 nt
    buffer_load_dwordx4 v[144:147], v4, s[52:55], s12 offen offset:2048 nt
    buffer_load_dwordx4 v[148:151], v4, s[52:55], s12 offen offset:3072 nt
    buffer_load_dwordx4 v[152:155], v4, s[52:55], s13 offen offset:0 nt
    buffer_load_dwordx4 v[156:159], v4, s[52:55], s13 offen offset:1024 nt
    buffer_load_dwordx4 v[160:163], v4, s[52:55], s13 offen offset:2048 nt
    buffer_load_dwordx4 v[164:167], v4, s[52:55], s13 offen offset:3072 nt
    s_waitcnt vmcnt(6)
    v_perm_b32 v76, v140, v136, s76
    v_perm_b32 v80, v140, v136, s77
    v_perm_b32 v84, v141, v137, s76
    v_perm_b32 v88, v141, v137, s77
    v_perm_b32 v92, v142, v138, s76
    v_perm_b32 v96, v142, v138, s77
    v_perm_b32 v100, v143, v139, s76
    v_perm_b32 v104, v143, v139, s77
    s_waitcnt vmcnt(4)
    v_perm_b32 v77, v148, v144, s76
    v_perm_b32 v81, v148, v144, s77
    v_perm_b32 v85, v149, v145, s76
    v_perm_b32 v89, v149, v145, s77
    v_perm_b32 v93, v150, v146, s76
    v_perm_b32 v97, v150, v146, s77
    v_perm_b32 v101, v151, v147, s76
    v_perm_b32 v105, v151, v147, s77
    s_waitcnt vmcnt(2)
    v_perm_b32 v78, v156, v152, s76
    v_perm_b32 v82, v156, v152, s77
    v_perm_b32 v86, v157, v153, s76
    v_perm_b32 v90, v157, v153, s77
    v_perm_b32 v94, v158, v154, s76
    v_perm_b32 v98, v158, v154, s77
    v_perm_b32 v102, v159, v155, s76
    v_perm_b32 v106, v159, v155, s77
    s_waitcnt vmcnt(0)
    v_perm_b32 v79, v164, v160, s76
    v_perm_b32 v83, v164, v160, s77
    v_perm_b32 v87, v165, v161, s76
    v_perm_b32 v91, v165, v161, s77
    v_perm_b32 v95, v166, v162, s76
    v_perm_b32 v99, v166, v162, s77
    v_perm_b32 v103, v167, v163, s76
    v_perm_b32 v107, v167, v163, s77
    s_waitcnt lgkmcnt(0)
    v_mfma_f32_16x16x32_bf16 v[76:79], v[72:75], v[76:79], 0
    v_mfma_f32_16x16x32_bf16 v[80:83], v[72:75], v[80:83], 0
    v_mfma_f32_16x16x32_bf16 v[84:87], v[72:75], v[84:87], 0
    v_mfma_f32_16x16x32_bf16 v[88:91], v[72:75], v[88:91], 0
    v_mfma_f32_16x16x32_bf16 v[92:95], v[72:75], v[92:95], 0
    v_mfma_f32_16x16x32_bf16 v[96:99], v[72:75], v[96:99], 0
    v_mfma_f32_16x16x32_bf16 v[100:103], v[72:75], v[100:103], 0
    v_mfma_f32_16x16x32_bf16 v[104:107], v[72:75], v[104:107], 0
    s_nop 0
    v_mov_b32 v8, v76
    v_mov_b32 v9, v80
    v_mov_b32 v10, v84
    v_mov_b32 v11, v88
    v_mov_b32 v12, v92
    v_mov_b32 v13, v96
    v_mov_b32 v14, v100
    v_mov_b32 v15, v104
    s_branch L_h1_out
L_h1_none:
    v_mov_b32 v8, 0
    v_mov_b32 v9, 0
    v_mov_b32 v10, 0
    v_mov_b32 v11, 0
    v_mov_b32 v12, 0
    v_mov_b32 v13, 0
    v_mov_b32 v14, 0
    v_mov_b32 v15, 0
L_h1_out:
    v_lshlrev_b32 v2, 4, v0
    ds_write_b128 v2, v[8:11] offset:2304
    ds_write_b128 v2, v[12:15] offset:3328
    s_waitcnt lgkmcnt(0)
    s_mov_b64 exec, 1
    ds_add_u32 v5, v6 offset:12
    s_mov_b64 exec, -1
    s_endpgm
L_h2:
    s_mov_b64 exec, 1
    ds_add_u32 v5, v6 offset:4
    s_mov_b64 exec, -1
    s_mov_b32 s44, s24
    s_mov_b32 s45, s25
    s_mov_b32 s46, 0x400000
    s_mov_b32 s47, 0x20000
    v_lshlrev_b32 v2, 13, v7
    v_lshl_add_u32 v2, v1, 4, v2
    s_lshl_b32 s12, s95, 16
    s_lshl_b32 s4, s96, 8
    s_add_u32 s12, s12, s4
    s_add_u32 s13, s12, 4096
    s_add_u32 s14, s12, 32768
    s_add_u32 s15, s12, 36864
    v_lshlrev_b32 v44, 16, v7
    v_lshl_add_u32 v44, v1, 4, v44
    s_lshl_b32 s87, s96, 18
    s_lshl_b32 s4, s95, 8
    s_add_u32 s87, s87, s4
    s_add_u32 s87, s87, 0x300000
    s_add_u32 s88, s87, 16384
    s_add_u32 s89, s87, 32768
    s_add_u32 s90, s87, 49152
    v_lshrrev_b32 v47, 2, v1
    v_lshlrev_b32 v47, 7, v47
    v_lshl_add_u32 v47, v7, 4, v47
    v_lshlrev_b32 v46, 4, v0
    s_mov_b32 s5, 0
L_spin9:
    ds_read_b32 v4, v5 offset:32
    s_waitcnt lgkmcnt(0)
    v_readfirstlane_b32 s4, v4
    s_cmp_ge_u32 s4, 1
    s_cbranch_scc1 L_spin9_done
    s_sleep 1
    s_add_u32 s5, s5, 1
    s_cmp_lt_u32 s5, 8000000
    s_cbranch_scc1 L_spin9
L_spin9_done:
    buffer_load_dwordx4 v[8:11], v2, s[44:47], s12 offen offset:0 nt
    buffer_load_dwordx4 v[12:15], v2, s[44:47], s12 offen offset:1024 nt
    buffer_load_dwordx4 v[16:19], v2, s[44:47], s12 offen offset:2048 nt
    buffer_load_dwordx4 v[20:23], v2, s[44:47], s12 offen offset:3072 nt
    buffer_load_dwordx4 v[24:27], v2, s[44:47], s13 offen offset:0 nt
    buffer_load_dwordx4 v[28:31], v2, s[44:47], s13 offen offset:1024 nt
    buffer_load_dwordx4 v[32:35], v2, s[44:47], s13 offen offset:2048 nt
    buffer_load_dwordx4 v[36:39], v2, s[44:47], s13 offen offset:3072 nt
    buffer_load_dwordx4 v[104:107], v2, s[44:47], s14 offen offset:0 nt
    buffer_load_dwordx4 v[108:111], v2, s[44:47], s14 offen offset:1024 nt
    buffer_load_dwordx4 v[112:115], v2, s[44:47], s14 offen offset:2048 nt
    buffer_load_dwordx4 v[116:119], v2, s[44:47], s14 offen offset:3072 nt
    buffer_load_dwordx4 v[120:123], v2, s[44:47], s15 offen offset:0 nt
    buffer_load_dwordx4 v[124:127], v2, s[44:47], s15 offen offset:1024 nt
    buffer_load_dwordx4 v[128:131], v2, s[44:47], s15 offen offset:2048 nt
    buffer_load_dwordx4 v[132:135], v2, s[44:47], s15 offen offset:3072 nt
    s_waitcnt vmcnt(14)
    v_perm_b32 v72, v12, v8, s76
    v_perm_b32 v76, v12, v8, s77
    v_perm_b32 v80, v13, v9, s76
    v_perm_b32 v84, v13, v9, s77
    v_perm_b32 v88, v14, v10, s76
    v_perm_b32 v92, v14, v10, s77
    v_perm_b32 v96, v15, v11, s76
    v_perm_b32 v100, v15, v11, s77
    s_waitcnt vmcnt(12)
    v_perm_b32 v73, v20, v16, s76
    v_perm_b32 v77, v20, v16, s77
    v_perm_b32 v81, v21, v17, s76
    v_perm_b32 v85, v21, v17, s77
    v_perm_b32 v89, v22, v18, s76
    v_perm_b32 v93, v22, v18, s77
    v_perm_b32 v97, v23, v19, s76
    v_perm_b32 v101, v23, v19, s77
    s_waitcnt vmcnt(10)
    v_perm_b32 v74, v28, v24, s76
    v_perm_b32 v78, v28, v24, s77
    v_perm_b32 v82, v29, v25, s76
    v_perm_b32 v86, v29, v25, s77
    v_perm_b32 v90, v30, v26, s76
    v_perm_b32 v94, v30, v26, s77
    v_perm_b32 v98, v31, v27, s76
    v_perm_b32 v102, v31, v27, s77
    s_waitcnt vmcnt(8)
    v_perm_b32 v75, v36, v32, s76
    v_perm_b32 v79, v36, v32, s77
    v_perm_b32 v83, v37, v33, s76
    v_perm_b32 v87, v37, v33, s77
    v_perm_b32 v91, v38, v34, s76
    v_perm_b32 v95, v38, v34, s77
    v_perm_b32 v99, v39, v35, s76
    v_perm_b32 v103, v39, v35, s77
    s_waitcnt vmcnt(6)
    v_perm_b32 v8, v108, v104, s76
    v_perm_b32 v12, v108, v104, s77
    v_perm_b32 v16, v109, v105, s76
    v_perm_b32 v20, v109, v105, s77
    v_perm_b32 v24, v110, v106, s76
    v_perm_b32 v28, v110, v106, s77
    v_perm_b32 v32, v111, v107, s76
    v_perm_b32 v36, v111, v107, s77
    s_waitcnt vmcnt(4)
    v_perm_b32 v9, v116, v112, s76
    v_perm_b32 v13, v116, v112, s77
    v_perm_b32 v17, v117, v113, s76
    v_perm_b32 v21, v117, v113, s77
    v_perm_b32 v25, v118, v114, s76
    v_perm_b32 v29, v118, v114, s77
    v_perm_b32 v33, v119, v115, s76
    v_perm_b32 v37, v119, v115, s77
    s_waitcnt vmcnt(2)
    v_perm_b32 v10, v124, v120, s76
    v_perm_b32 v14, v124, v120, s77
    v_perm_b32 v18, v125, v121, s76
    v_perm_b32 v22, v125, v121, s77
    v_perm_b32 v26, v126, v122, s76
    v_perm_b32 v30, v126, v122, s77
    v_perm_b32 v34, v127, v123, s76
    v_perm_b32 v38, v127, v123, s77
    s_waitcnt vmcnt(0)
    v_perm_b32 v11, v132, v128, s76
    v_perm_b32 v15, v132, v128, s77
    v_perm_b32 v19, v133, v129, s76
    v_perm_b32 v23, v133, v129, s77
    v_perm_b32 v27, v134, v130, s76
    v_perm_b32 v31, v134, v130, s77
    v_perm_b32 v35, v135, v131, s76
    v_perm_b32 v39, v135, v131, s77
    s_mov_b32 s5, 0
L_spin10:
    ds_read_b32 v4, v5 offset:12
    s_waitcnt lgkmcnt(0)
    v_readfirstlane_b32 s4, v4
    s_cmp_ge_u32 s4, 1
    s_cbranch_scc1 L_spin10_done
    s_sleep 2
    s_add_u32 s5, s5, 1
    s_cmp_lt_u32 s5, 8000000
    s_cbranch_scc1 L_spin10
L_spin10_done:
    ds_read_b128 v[48:51], v46 offset:2304
    ds_read_b128 v[52:55], v46 offset:3328
    v_mov_b32 v106, s42
    v_mov_b32 v107, s43
    v_mov_b32 v110, s42
    v_mov_b32 v111, s43
    v_mov_b32 v114, s42
    v_mov_b32 v115, s43
    v_mov_b32 v118, s42
    v_mov_b32 v119, s43
    s_mov_b32 s5, 0
L_spin11:
    ds_read_b32 v4, v5 offset:16
    s_waitcnt lgkmcnt(0)
    v_readfirstlane_b32 s4, v4
    s_cmp_ge_u32 s4, 4
    s_cbranch_scc1 L_spin11_done
    s_add_u32 s5, s5, 1
    s_cmp_lt_u32 s5, 8000000
    s_cbranch_scc1 L_spin11
L_spin11_done:
    ds_read_b128 v[64:67], v47 offset:1792
    ds_read_b128 v[68:71], v47 offset:1856
    s_waitcnt lgkmcnt(1)
    v_mfma_f32_16x16x32_bf16 v[72:75], v[64:67], v[72:75], 0
    v_mfma_f32_16x16x32_bf16 v[76:79], v[64:67], v[76:79], 0
    v_mfma_f32_16x16x32_bf16 v[80:83], v[64:67], v[80:83], 0
    v_mfma_f32_16x16x32_bf16 v[84:87], v[64:67], v[84:87], 0
    v_mfma_f32_16x16x32_bf16 v[88:91], v[64:67], v[88:91], 0
    v_mfma_f32_16x16x32_bf16 v[92:95], v[64:67], v[92:95], 0
    v_mfma_f32_16x16x32_bf16 v[96:99], v[64:67], v[96:99], 0
    v_mfma_f32_16x16x32_bf16 v[100:103], v[64:67], v[100:103], 0
    s_waitcnt lgkmcnt(0)
    v_mfma_f32_16x16x32_bf16 v[72:75], v[68:71], v[8:11], v[72:75]
    v_mfma_f32_16x16x32_bf16 v[76:79], v[68:71], v[12:15], v[76:79]
    v_mfma_f32_16x16x32_bf16 v[80:83], v[68:71], v[16:19], v[80:83]
    v_mfma_f32_16x16x32_bf16 v[84:87], v[68:71], v[20:23], v[84:87]
    s_nop 4
    v_add_f32 v104, v72, v48
    v_add_f32 v105, v76, v49
    buffer_store_dwordx4 v[104:107], v44, s[56:59], s87 offen sc1
    v_mfma_f32_16x16x32_bf16 v[88:91], v[68:71], v[24:27], v[88:91]
    v_mfma_f32_16x16x32_bf16 v[92:95], v[68:71], v[28:31], v[92:95]
    v_add_f32 v108, v80, v50
    v_add_f32 v109, v84, v51
    buffer_store_dwordx4 v[108:111], v44, s[56:59], s88 offen sc1
    v_mfma_f32_16x16x32_bf16 v[96:99], v[68:71], v[32:35], v[96:99]
    v_mfma_f32_16x16x32_bf16 v[100:103], v[68:71], v[36:39], v[100:103]
    s_nop 1
    v_add_f32 v112, v88, v52
    v_add_f32 v113, v92, v53
    buffer_store_dwordx4 v[112:115], v44, s[56:59], s89 offen sc1
    s_nop 1
    v_add_f32 v116, v96, v54
    v_add_f32 v117, v100, v55
    buffer_store_dwordx4 v[116:119], v44, s[56:59], s90 offen sc1
    s_mov_b64 exec, 1
    ds_add_u32 v5, v6 offset:44
    s_mov_b64 exec, -1
    s_endpgm
L_h3:
    s_mov_b64 exec, 1
    ds_add_u32 v5, v6 offset:4
    s_mov_b64 exec, -1
    s_mov_b32 s52, s34
    s_mov_b32 s53, s35
    s_mov_b32 s54, 0x1000
    s_mov_b32 s55, 0x20000
    s_bfe_u32 s4, s2, 0x20002
    s_lshl_b32 s86, s4, 10
    s_and_b32 s4, s2, 3
    s_lshl_b32 s4, s4, 8
    s_add_u32 s86, s86, s4
    s_lshl_b32 s4, s96, 6
    s_add_u32 s86, s86, s4
    s_bfe_u32 s4, s2, 0x20004
    s_lshl_b32 s4, s4, 2
    s_add_u32 s86, s86, s4
    v_and_b32 v40, 3, v0
    v_lshlrev_b32 v40, 4, v40
    buffer_load_dword v41, v40, s[48:51], s86 offen
    buffer_load_dword v43, v40, s[52:55], s86 offen
    s_and_b32 s4, s2, 3
    s_lshl_b32 s88, s4, 18
    s_bfe_u32 s4, s2, 0x20002
    s_lshl_b32 s4, s4, 16
    s_add_u32 s88, s88, s4
    s_bfe_u32 s4, s2, 0x20004
    s_lshl_b32 s4, s4, 14
    s_add_u32 s88, s88, s4
    s_add_u32 s88, s88, 0x300000
    v_lshrrev_b32 v45, 2, v0
    v_lshl_add_u32 v45, v45, 8, v40
    s_lshl_b32 s4, s96, 6
    s_add_u32 s88, s88, s4
    s_add_u32 s89, s88, 4096
    s_add_u32 s90, s88, 8192
    s_add_u32 s91, s88, 12288
    s_waitcnt vmcnt(0)
    v_lshlrev_b32 v56, 16, v41
    v_and_b32 v57, s81, v41
    v_and_b32 v2, 31, v0
    v_lshlrev_b32 v2, 9, v2
    s_lshl_b32 s8, s95, 14
    s_add_u32 s8, s8, 0x200000
    s_mov_b32 s5, 0
L_spin12:
    ds_read_b32 v4, v5 offset:8
    s_waitcnt lgkmcnt(0)
    v_readfirstlane_b32 s4, v4
    s_cmp_ge_u32 s4, 8
    s_cbranch_scc1 L_spin12_done
    s_sleep 2
    s_add_u32 s5, s5, 1
    s_cmp_lt_u32 s5, 8000000
    s_cbranch_scc1 L_spin12
L_spin12_done:
    s_mov_b64 exec, 1
    ds_add_u32 v5, v6 offset:32
    s_mov_b64 exec, -1
    s_mov_b32 s5, 0
L_spin13:
    ds_read_b32 v4, v5 offset:44
    s_waitcnt lgkmcnt(0)
    v_readfirstlane_b32 s4, v4
    s_cmp_ge_u32 s4, 1
    s_cbranch_scc1 L_spin13_done
    s_sleep 1
    s_add_u32 s5, s5, 1
    s_cmp_lt_u32 s5, 8000000
    s_cbranch_scc1 L_spin13
L_spin13_done:
    s_sleep 12
    s_mov_b32 s9, 0
    buffer_load_dwordx4 v[120:123], v45, s[56:59], s88 offen sc1
    buffer_load_dwordx4 v[124:127], v45, s[56:59], s89 offen sc1
    buffer_load_dwordx4 v[128:131], v45, s[56:59], s90 offen sc1
    buffer_load_dwordx4 v[132:135], v45, s[56:59], s91 offen sc1
L_op:
    s_waitcnt vmcnt(0)
    v_cmp_ne_u64 s[16:17], v[122:123], s[42:43]
    v_cmp_ne_u64 s[18:19], v[126:127], s[42:43]
    v_cmp_ne_u64 s[20:21], v[130:131], s[42:43]
    v_cmp_ne_u64 s[22:23], v[134:135], s[42:43]
    s_or_b64 s[6:7], s[16:17], s[18:19]
    s_or_b64 s[6:7], s[6:7], s[20:21]
    s_or_b64 s[6:7], s[6:7], s[22:23]
    s_cmp_eq_u64 s[6:7], 0
    s_cbranch_scc1 L_op_done
    s_add_u32 s9, s9, 1
    s_cmp_ge_u32 s9, 2000000
    s_cbranch_scc1 L_op_done
    s_mov_b64 exec, s[16:17]
    s_cbranch_execz L_op_sk0
    buffer_load_dwordx4 v[120:123], v45, s[56:59], s88 offen sc1
L_op_sk0:
    s_mov_b64 exec, s[18:19]
    s_cbranch_execz L_op_sk1
    buffer_load_dwordx4 v[124:127], v45, s[56:59], s89 offen sc1
L_op_sk1:
    s_mov_b64 exec, s[20:21]
    s_cbranch_execz L_op_sk2
    buffer_load_dwordx4 v[128:131], v45, s[56:59], s90 offen sc1
L_op_sk2:
    s_mov_b64 exec, s[22:23]
    s_cbranch_execz L_op_sk3
    buffer_load_dwordx4 v[132:135], v45, s[56:59], s91 offen sc1
L_op_sk3:
    s_mov_b64 exec, -1
    s_branch L_op
L_op_done:
    v_add_f32 v120, v120, v124
    v_add_f32 v128, v128, v132
    v_add_f32 v121, v121, v125
    v_add_f32 v129, v129, v133
    v_add_f32 v120, v120, v128
    v_add_f32 v121, v121, v129
    s_nop 0
    v_add_f32_dpp v120, v120, v120 row_ror:4 row_mask:0xf bank_mask:0xf
    v_add_f32_dpp v121, v121, v121 row_ror:4 row_mask:0xf bank_mask:0xf
    s_nop 0
    v_add_f32_dpp v120, v120, v120 row_ror:8 row_mask:0xf bank_mask:0xf
    v_add_f32_dpp v121, v121, v121 row_ror:8 row_mask:0xf bank_mask:0xf
    v_mov_b32 v124, v120
    v_mov_b32 v125, v121
    s_nop 0
    v_permlane16_swap_b32 v120, v124
    v_permlane16_swap_b32 v121, v125
    v_add_f32 v120, v120, v124
    v_add_f32 v121, v121, v125
    v_mov_b32 v124, v120
    v_mov_b32 v125, v121
    s_nop 0
    v_permlane32_swap_b32 v120, v124
    v_permlane32_swap_b32 v121, v125
    v_add_f32 v120, v120, v124
    v_add_f32 v121, v121, v125
    v_add_f32 v56, v56, v120
    v_add_f32 v57, v57, v121
    v_cvt_pk_bf16_f32 v46, v56, v57
    s_mov_b64 exec, 0xf
    buffer_store_dword v46, v40, s[52:55], s86 offen
    s_cmp_lg_u32 s2, 0
    s_cbranch_scc1 L_h3_fin
    s_mov_b64 exec, 1
    v_mov_b32 v46, s42
    v_mov_b32 v47, s43
    buffer_store_dwordx2 v[46:47], v5, s[56:59], 0 offen sc1
L_h3_fin:
    s_mov_b64 exec, -1
L_end:
    s_endpgm
L_code_end:
.section .rodata,"a"
.p2align 6
.amdhsa_kernel parallel_sum__gqa_block_cached__glu_gated_swiglu__decode_kernel
.amdhsa_next_free_vgpr 168
.amdhsa_next_free_sgpr 102
.amdhsa_accum_offset 168
.amdhsa_group_segment_fixed_size 0
.amdhsa_float_denorm_mode_32 3
.amdhsa_kernarg_size 96
.amdhsa_user_sgpr_count 2
.amdhsa_user_sgpr_kernarg_segment_ptr 1
.amdhsa_system_sgpr_workgroup_id_x 1
.end_amdhsa_kernel
```
